```python
import torch

def _softmax(x, axis=-1):
    return torch.softmax(x, dim=axis)
def _gelu(x):
    return torch.nn.functional.gelu(x, approximate="tanh")
def _silu(x):
    return torch.nn.functional.silu(x)
def _sigmoid(x):
    return torch.sigmoid(x)
def _layernorm(x, axis=-1, eps=1e-5):
    m = x.mean(dim=axis, keepdim=True)
    v = x.var(dim=axis, keepdim=True, unbiased=False)
    return (x - m) / torch.sqrt(v + eps)
def _scatter_add(tgt, idx, src, axis=0):
    return tgt.clone().index_add_(axis, idx, src)
def _segment_sum(src, seg, n):
    out = torch.zeros((n,) + src.shape[1:], dtype=src.dtype)
    return out.index_add_(0, seg, src)
def _pad(x, pw):
    flat = tuple(v for pair in reversed(pw) for v in pair)
    return torch.nn.functional.pad(x, flat)

kernel_name = 'standalone__gqa_softmax__near_ridge'

def setup_inputs():

    _w = (lambda a: (lambda t: t.to(torch.bfloat16) if t.is_floating_point() else t)(torch.as_tensor(a)))
    B, Hq, Hkv, Sq, Sk, D = 16, 16, 8, 512, 512, 256
    return {
        "q": _w((lambda *s: torch.randn(*s, dtype=torch.bfloat16) * 0.8)(B, Hq, Sq, D)),
        "k": _w((lambda *s: torch.randn(*s, dtype=torch.bfloat16) * 0.8)(B, Hkv, Sk, D)),
        "v": _w((lambda *s: torch.randn(*s, dtype=torch.bfloat16) * 0.05)(B, Hkv, Sk, D)),
    }

def reference(q, k, v):
    B, Hq, Sq, D = q.shape
    Hkv = k.shape[1]
    rep = Hq // Hkv
    k = (lambda x, n, axis: torch.repeat_interleave(x, n, dim=axis))(k, rep, axis=1)
    v = (lambda x, n, axis: torch.repeat_interleave(x, n, dim=axis))(v, rep, axis=1)
    scale = D ** -0.5
    scores = torch.einsum("bhqd,bhkd->bhqk", q, k) * scale
    p = _softmax(scores, axis=-1)
    return torch.einsum("bhqk,bhkd->bhqd", p, v)
```

```asm
; @launch grid=(256,1,1) block=(256,1,1) lds=163840
.amdgcn_target "amdgcn-amd-amdhsa--gfx950"
.text
.globl standalone__gqa_softmax__near_ridge_kernel
.p2align 8
.type standalone__gqa_softmax__near_ridge_kernel,@function
standalone__gqa_softmax__near_ridge_kernel:
    s_cmp_ge_u32 s2, 256
    s_cbranch_scc1 L_end
    s_getpc_b64 s[90:91]
L_pc_here:
    v_lshlrev_b32 v62, 7, v0
    v_min_u32 v62, (L_code_end - L_pc_here - 4), v62
    global_load_dword v63, v62, s[90:91]
    s_load_dwordx2 s[4:5], s[0:1], 0
    s_load_dwordx2 s[8:9], s[0:1], 8
    s_load_dwordx2 s[12:13], s[0:1], 16
    s_load_dwordx2 s[16:17], s[0:1], 24
    v_lshrrev_b32 v25, 6, v0
    v_and_b32 v22, 63, v0
    v_readfirstlane_b32 s20, v25
    s_mov_b32 s6, 67108864
    s_mov_b32 s7, 131072
    s_mov_b32 s10, 33554432
    s_mov_b32 s11, 131072
    s_mov_b32 s14, 33554432
    s_mov_b32 s15, 131072
    s_mov_b32 s18, 67108864
    s_mov_b32 s19, 131072
    s_and_b32 s33, s2, 7
    s_lshr_b32 s34, s2, 3
    s_and_b32 s37, s34, 3
    s_lshr_b32 s34, s34, 2
    s_and_b32 s76, s34, 1
    s_lshl_b32 s33, s33, 3
    s_add_u32 s36, s33, s34
    s_lshl_b32 s21, s20, 10
    s_lshl_b32 s32, s36, 18
    s_lshl_b32 s28, s36, 19
    s_lshl_b32 s34, s37, 17
    s_add_u32 s28, s28, s34
    s_lshl_b32 s34, s20, 15
    s_add_u32 s28, s28, s34
    s_mul_i32 s39, s20, 24576
    s_add_u32 s39, s39, 65536
    s_add_u32 s82, s28, 0
    s_add_u32 s83, s28, 4096
    s_add_u32 s84, s28, 8192
    s_add_u32 s85, s28, 12288
    s_add_u32 s86, s28, 16384
    s_add_u32 s87, s28, 20480
    s_add_u32 s88, s28, 24576
    s_add_u32 s89, s28, 28672
    v_lshrrev_b32 v28, 3, v22
    v_and_b32 v27, 7, v22
    v_lshrrev_b32 v25, 4, v22
    v_xor_b32 v26, v25, v27
    v_lshlrev_b32 v26, 4, v26
    v_lshlrev_b32 v29, 9, v28
    v_add_u32 v51, v29, v26
    v_xor_b32 v31, 64, v51
    s_lshl_b32 s33, s20, 3
    v_add_u32 v28, s33, v28
    v_lshrrev_b32 v25, 1, v28
    v_and_b32 v26, 7, v25
    v_xor_b32 v26, v26, v27
    v_lshlrev_b32 v26, 4, v26
    v_lshlrev_b32 v29, 9, v28
    v_add_u32 v8, v29, v26
    v_and_b32 v26, 3, v25
    v_lshlrev_b32 v26, 1, v26
    v_xor_b32 v26, v26, v27
    v_lshlrev_b32 v26, 4, v26
    v_add_u32 v9, v29, v26
    s_waitcnt lgkmcnt(0)
    s_add_u32 m0, s21, 0
    s_nop 0
    buffer_load_dwordx4 v8, s[8:11], s32 offen offset:0 lds
    s_add_u32 m0, s21, 3968
    s_nop 0
    buffer_load_dwordx4 v8, s[8:11], s32 offen offset:128 lds
    s_add_u32 m0, s21, 7936
    s_nop 0
    buffer_load_dwordx4 v8, s[8:11], s32 offen offset:256 lds
    s_add_u32 m0, s21, 11904
    s_nop 0
    buffer_load_dwordx4 v8, s[8:11], s32 offen offset:384 lds
    s_lshl_b32 s35, s20, 13
    s_add_u32 s35, s35, 32768
    s_add_u32 m0, s35, 0
    s_nop 0
    buffer_load_dwordx4 v51, s[4:7], s82 offen offset:0 nt lds
    s_add_u32 m0, s35, 1024
    s_nop 0
    buffer_load_dwordx4 v31, s[4:7], s83 offen offset:0 nt lds
    s_add_u32 m0, s35, 2048
    s_nop 0
    buffer_load_dwordx4 v51, s[4:7], s84 offen offset:0 nt lds
    s_add_u32 m0, s35, 3072
    s_nop 0
    buffer_load_dwordx4 v31, s[4:7], s85 offen offset:0 nt lds
    s_add_u32 m0, s35, 4096
    s_nop 0
    buffer_load_dwordx4 v51, s[4:7], s86 offen offset:0 nt lds
    s_add_u32 m0, s35, 5120
    s_nop 0
    buffer_load_dwordx4 v31, s[4:7], s87 offen offset:0 nt lds
    s_add_u32 m0, s35, 6144
    s_nop 0
    buffer_load_dwordx4 v51, s[4:7], s88 offen offset:0 nt lds
    s_add_u32 m0, s35, 7168
    s_nop 0
    buffer_load_dwordx4 v31, s[4:7], s89 offen offset:0 nt lds
    s_add_u32 m0, s39, -128
    s_nop 0
    buffer_load_dwordx4 v51, s[4:7], s82 offen offset:128 nt lds
    s_add_u32 m0, s39, 896
    s_nop 0
    buffer_load_dwordx4 v31, s[4:7], s83 offen offset:128 nt lds
    s_add_u32 m0, s39, 1920
    s_nop 0
    buffer_load_dwordx4 v51, s[4:7], s84 offen offset:128 nt lds
    s_add_u32 m0, s39, 2944
    s_nop 0
    buffer_load_dwordx4 v31, s[4:7], s85 offen offset:128 nt lds
    s_add_u32 m0, s39, 3968
    s_nop 0
    buffer_load_dwordx4 v51, s[4:7], s86 offen offset:128 nt lds
    s_add_u32 m0, s39, 4992
    s_nop 0
    buffer_load_dwordx4 v31, s[4:7], s87 offen offset:128 nt lds
    s_add_u32 m0, s39, 6016
    s_nop 0
    buffer_load_dwordx4 v51, s[4:7], s88 offen offset:128 nt lds
    s_add_u32 m0, s39, 7040
    s_nop 0
    buffer_load_dwordx4 v31, s[4:7], s89 offen offset:128 nt lds
    s_add_u32 m0, s39, 7936
    s_nop 0
    buffer_load_dwordx4 v51, s[4:7], s82 offen offset:256 nt lds
    s_add_u32 m0, s39, 8960
    s_nop 0
    buffer_load_dwordx4 v31, s[4:7], s83 offen offset:256 nt lds
    s_add_u32 m0, s39, 9984
    s_nop 0
    buffer_load_dwordx4 v51, s[4:7], s84 offen offset:256 nt lds
    s_add_u32 m0, s39, 11008
    s_nop 0
    buffer_load_dwordx4 v31, s[4:7], s85 offen offset:256 nt lds
    s_add_u32 m0, s39, 12032
    s_nop 0
    buffer_load_dwordx4 v51, s[4:7], s86 offen offset:256 nt lds
    s_add_u32 m0, s39, 13056
    s_nop 0
    buffer_load_dwordx4 v31, s[4:7], s87 offen offset:256 nt lds
    s_add_u32 m0, s39, 14080
    s_nop 0
    buffer_load_dwordx4 v51, s[4:7], s88 offen offset:256 nt lds
    s_add_u32 m0, s39, 15104
    s_nop 0
    buffer_load_dwordx4 v31, s[4:7], s89 offen offset:256 nt lds
    v_and_b32 v23, 15, v22
    v_lshrrev_b32 v24, 4, v22
    v_lshrrev_b32 v25, 1, v23
    v_add_u32 v26, 0, v24
    v_xor_b32 v26, v26, v25
    v_lshlrev_b32 v26, 4, v26
    v_lshlrev_b32 v27, 7, v23
    v_add_u32 v2, v26, v27
    v_add_u32 v26, 4, v24
    v_xor_b32 v26, v26, v25
    v_lshlrev_b32 v26, 4, v26
    v_lshlrev_b32 v27, 7, v23
    v_add_u32 v3, v26, v27
    v_lshrrev_b32 v25, 2, v23
    v_lshlrev_b32 v28, 2, v24
    v_add_u32 v28, v28, v25
    v_lshrrev_b32 v25, 1, v28
    v_and_b32 v25, 3, v25
    v_and_b32 v27, 3, v23
    v_lshlrev_b32 v27, 3, v27
    v_lshlrev_b32 v28, 7, v28
    v_add_u32 v28, v28, v27
    v_xor_b32 v26, 0, v25
    v_lshlrev_b32 v26, 5, v26
    v_add_u32 v4, v26, v28
    v_xor_b32 v26, 1, v25
    v_lshlrev_b32 v26, 5, v26
    v_add_u32 v5, v26, v28
    v_xor_b32 v26, 2, v25
    v_lshlrev_b32 v26, 5, v26
    v_add_u32 v6, v26, v28
    v_xor_b32 v26, 3, v25
    v_lshlrev_b32 v26, 5, v26
    v_add_u32 v7, v26, v28
    v_lshlrev_b32 v25, 9, v23
    v_lshlrev_b32 v26, 4, v24
    v_add_u32 v48, v25, v26
    v_and_b32 v26, 1, v24
    v_lshlrev_b32 v26, 3, v26
    v_add_u32 v25, v25, v26
    v_add_u32 v61, s39, v25
    v_lshrrev_b32 v25, 1, v24
    v_and_b32 v26, 7, v23
    v_xor_b32 v25, v25, v26
    v_lshlrev_b32 v25, 4, v25
    v_add_u32 v61, v61, v25
    v_lshrrev_b32 v25, 5, v22
    v_and_b32 v26, 31, v22
    v_xor_b32 v26, v26, v25
    v_lshlrev_b32 v26, 4, v26
    v_lshlrev_b32 v25, 9, v25
    v_add_u32 v25, v25, v26
    v_add_u32 v49, s39, v25
    v_lshlrev_b32 v50, 4, v22
    s_mov_b32 s26, 0x3db8aa3b
    s_mov_b32 s27, 0x47800000
    s_add_u32 s30, s32, 262144
    s_add_u32 s31, s32, 16777216
    s_mov_b32 s29, s32
    s_add_u32 s22, s32, 32768
    s_add_u32 s23, s32, 16384
    s_add_u32 s38, s28, 33554432
    s_mov_b32 s72, s38
    s_mov_b32 s73, s39
    s_waitcnt vmcnt(24)
    s_barrier
    s_waitcnt vmcnt(16)
    v_add_u32 v28, s35, v2
    v_add_u32 v29, s35, v3
    ds_read_b128 a[0:3], v28 offset:0
    ds_read_b128 a[32:35], v28 offset:2048
    ds_read_b128 a[64:67], v28 offset:4096
    ds_read_b128 a[96:99], v28 offset:6144
    ds_read_b128 a[4:7], v29 offset:0
    ds_read_b128 a[36:39], v29 offset:2048
    ds_read_b128 a[68:71], v29 offset:4096
    ds_read_b128 a[100:103], v29 offset:6144
    ds_read_b128 v[32:35], v2 offset:0
    ds_read_b128 v[36:39], v2 offset:2048
    ds_read_b128 v[40:43], v3 offset:0
    ds_read_b128 v[44:47], v3 offset:2048
    s_add_u32 m0, s39, 16000
    s_nop 0
    buffer_load_dwordx4 v51, s[4:7], s82 offen offset:384 nt lds
    s_add_u32 m0, s39, 17024
    s_nop 0
    buffer_load_dwordx4 v31, s[4:7], s83 offen offset:384 nt lds
    s_add_u32 m0, s39, 18048
    s_nop 0
    buffer_load_dwordx4 v51, s[4:7], s84 offen offset:384 nt lds
    s_add_u32 m0, s39, 19072
    s_nop 0
    buffer_load_dwordx4 v31, s[4:7], s85 offen offset:384 nt lds
    s_add_u32 m0, s39, 20096
    s_nop 0
    buffer_load_dwordx4 v51, s[4:7], s86 offen offset:384 nt lds
    s_add_u32 m0, s39, 21120
    s_nop 0
    buffer_load_dwordx4 v31, s[4:7], s87 offen offset:384 nt lds
    s_add_u32 m0, s39, 22144
    s_nop 0
    buffer_load_dwordx4 v51, s[4:7], s88 offen offset:384 nt lds
    s_add_u32 m0, s39, 23168
    s_nop 0
    buffer_load_dwordx4 v31, s[4:7], s89 offen offset:384 nt lds
    s_add_u32 s33, s32, 16384
    s_add_u32 m0, s21, 16384
    s_nop 0
    buffer_load_dwordx4 v8, s[8:11], s33 offen offset:0 lds
    s_add_u32 m0, s21, 20352
    s_nop 0
    buffer_load_dwordx4 v8, s[8:11], s33 offen offset:128 lds
    s_add_u32 m0, s21, 24320
    s_nop 0
    buffer_load_dwordx4 v8, s[8:11], s33 offen offset:256 lds
    s_add_u32 m0, s21, 28288
    s_nop 0
    buffer_load_dwordx4 v8, s[8:11], s33 offen offset:384 lds
    s_waitcnt lgkmcnt(0)
    v_mfma_f32_16x16x32_bf16 v[88:91], v[32:35], a[96:99], 0
    v_mfma_f32_16x16x32_bf16 v[80:83], v[32:35], a[64:67], 0
    v_mfma_f32_16x16x32_bf16 v[72:75], v[32:35], a[32:35], 0
    v_mfma_f32_16x16x32_bf16 v[64:67], v[32:35], a[0:3], 0
    v_mfma_f32_16x16x32_bf16 v[68:71], v[36:39], a[0:3], 0
    v_mfma_f32_16x16x32_bf16 v[76:79], v[36:39], a[32:35], 0
    v_mfma_f32_16x16x32_bf16 v[84:87], v[36:39], a[64:67], 0
    v_mfma_f32_16x16x32_bf16 v[92:95], v[36:39], a[96:99], 0
    v_mfma_f32_16x16x32_bf16 v[88:91], v[40:43], a[100:103], v[88:91]
    v_mfma_f32_16x16x32_bf16 v[80:83], v[40:43], a[68:71], v[80:83]
    v_mfma_f32_16x16x32_bf16 v[72:75], v[40:43], a[36:39], v[72:75]
    v_mfma_f32_16x16x32_bf16 v[64:67], v[40:43], a[4:7], v[64:67]
    v_mfma_f32_16x16x32_bf16 v[68:71], v[44:47], a[4:7], v[68:71]
    v_mfma_f32_16x16x32_bf16 v[76:79], v[44:47], a[36:39], v[76:79]
    v_mfma_f32_16x16x32_bf16 v[84:87], v[44:47], a[68:71], v[84:87]
    v_mfma_f32_16x16x32_bf16 v[92:95], v[44:47], a[100:103], v[92:95]
    s_waitcnt vmcnt(20)
    v_add_u32 v28, s39, v2
    v_add_u32 v29, s39, v3
    ds_read_b128 a[8:11], v28 offset:0
    ds_read_b128 a[40:43], v28 offset:2048
    ds_read_b128 a[72:75], v28 offset:4096
    ds_read_b128 a[104:107], v28 offset:6144
    ds_read_b128 a[12:15], v29 offset:0
    ds_read_b128 a[44:47], v29 offset:2048
    ds_read_b128 a[76:79], v29 offset:4096
    ds_read_b128 a[108:111], v29 offset:6144
    ds_read_b128 v[32:35], v2 offset:4096
    ds_read_b128 v[36:39], v2 offset:6144
    ds_read_b128 v[40:43], v3 offset:4096
    ds_read_b128 v[44:47], v3 offset:6144
    s_waitcnt lgkmcnt(0)
    s_barrier
    s_add_u32 m0, s21, 32768
    s_nop 0
    buffer_load_dwordx4 v9, s[12:15], s32 offen offset:0 lds
    s_add_u32 m0, s21, 36736
    s_nop 0
    buffer_load_dwordx4 v9, s[12:15], s32 offen offset:128 lds
    s_add_u32 m0, s21, 40704
    s_nop 0
    buffer_load_dwordx4 v9, s[12:15], s32 offen offset:256 lds
    s_add_u32 m0, s21, 44672
    s_nop 0
    buffer_load_dwordx4 v9, s[12:15], s32 offen offset:384 lds
    v_mfma_f32_16x16x32_bf16 v[88:91], v[32:35], a[104:107], v[88:91]
    v_mfma_f32_16x16x32_bf16 v[80:83], v[32:35], a[72:75], v[80:83]
    v_mfma_f32_16x16x32_bf16 v[72:75], v[32:35], a[40:43], v[72:75]
    v_mfma_f32_16x16x32_bf16 v[64:67], v[32:35], a[8:11], v[64:67]
    v_mfma_f32_16x16x32_bf16 v[68:71], v[36:39], a[8:11], v[68:71]
    v_mfma_f32_16x16x32_bf16 v[76:79], v[36:39], a[40:43], v[76:79]
    v_mfma_f32_16x16x32_bf16 v[84:87], v[36:39], a[72:75], v[84:87]
    v_mfma_f32_16x16x32_bf16 v[92:95], v[36:39], a[104:107], v[92:95]
    v_mfma_f32_16x16x32_bf16 v[88:91], v[40:43], a[108:111], v[88:91]
    v_mfma_f32_16x16x32_bf16 v[80:83], v[40:43], a[76:79], v[80:83]
    v_mfma_f32_16x16x32_bf16 v[72:75], v[40:43], a[44:47], v[72:75]
    v_mfma_f32_16x16x32_bf16 v[64:67], v[40:43], a[12:15], v[64:67]
    v_mfma_f32_16x16x32_bf16 v[68:71], v[44:47], a[12:15], v[68:71]
    v_mfma_f32_16x16x32_bf16 v[76:79], v[44:47], a[44:47], v[76:79]
    v_mfma_f32_16x16x32_bf16 v[84:87], v[44:47], a[76:79], v[84:87]
    v_mfma_f32_16x16x32_bf16 v[92:95], v[44:47], a[108:111], v[92:95]
    s_waitcnt vmcnt(16)
    ds_read_b128 a[16:19], v28 offset:8192
    ds_read_b128 a[48:51], v28 offset:10240
    ds_read_b128 a[80:83], v28 offset:12288
    ds_read_b128 a[112:115], v28 offset:14336
    ds_read_b128 a[20:23], v29 offset:8192
    ds_read_b128 a[52:55], v29 offset:10240
    ds_read_b128 a[84:87], v29 offset:12288
    ds_read_b128 a[116:119], v29 offset:14336
    ds_read_b128 v[32:35], v2 offset:8192
    ds_read_b128 v[36:39], v2 offset:10240
    ds_read_b128 v[40:43], v3 offset:8192
    ds_read_b128 v[44:47], v3 offset:10240
    s_waitcnt lgkmcnt(0)
    v_mfma_f32_16x16x32_bf16 v[88:91], v[32:35], a[112:115], v[88:91]
    v_mfma_f32_16x16x32_bf16 v[80:83], v[32:35], a[80:83], v[80:83]
    v_mfma_f32_16x16x32_bf16 v[72:75], v[32:35], a[48:51], v[72:75]
    v_mfma_f32_16x16x32_bf16 v[64:67], v[32:35], a[16:19], v[64:67]
    v_mfma_f32_16x16x32_bf16 v[68:71], v[36:39], a[16:19], v[68:71]
    v_mfma_f32_16x16x32_bf16 v[76:79], v[36:39], a[48:51], v[76:79]
    v_mfma_f32_16x16x32_bf16 v[84:87], v[36:39], a[80:83], v[84:87]
    v_mfma_f32_16x16x32_bf16 v[92:95], v[36:39], a[112:115], v[92:95]
    v_mfma_f32_16x16x32_bf16 v[88:91], v[40:43], a[116:119], v[88:91]
    v_mfma_f32_16x16x32_bf16 v[80:83], v[40:43], a[84:87], v[80:83]
    v_mfma_f32_16x16x32_bf16 v[72:75], v[40:43], a[52:55], v[72:75]
    v_mfma_f32_16x16x32_bf16 v[64:67], v[40:43], a[20:23], v[64:67]
    v_mfma_f32_16x16x32_bf16 v[68:71], v[44:47], a[20:23], v[68:71]
    v_mfma_f32_16x16x32_bf16 v[76:79], v[44:47], a[52:55], v[76:79]
    v_mfma_f32_16x16x32_bf16 v[84:87], v[44:47], a[84:87], v[84:87]
    v_mfma_f32_16x16x32_bf16 v[92:95], v[44:47], a[116:119], v[92:95]
    s_waitcnt vmcnt(8)
    ds_read_b128 a[24:27], v28 offset:16384
    ds_read_b128 a[56:59], v28 offset:18432
    ds_read_b128 a[88:91], v28 offset:20480
    ds_read_b128 a[120:123], v28 offset:22528
    ds_read_b128 a[28:31], v29 offset:16384
    ds_read_b128 a[60:63], v29 offset:18432
    ds_read_b128 a[92:95], v29 offset:20480
    ds_read_b128 a[124:127], v29 offset:22528
    ds_read_b128 v[32:35], v2 offset:12288
    ds_read_b128 v[36:39], v2 offset:14336
    ds_read_b128 v[40:43], v3 offset:12288
    ds_read_b128 v[44:47], v3 offset:14336
    s_waitcnt lgkmcnt(0)
    v_mfma_f32_16x16x32_bf16 v[88:91], v[32:35], a[120:123], v[88:91]
    v_mfma_f32_16x16x32_bf16 v[80:83], v[32:35], a[88:91], v[80:83]
    v_mfma_f32_16x16x32_bf16 v[72:75], v[32:35], a[56:59], v[72:75]
    v_mfma_f32_16x16x32_bf16 v[64:67], v[32:35], a[24:27], v[64:67]
    v_mfma_f32_16x16x32_bf16 v[68:71], v[36:39], a[24:27], v[68:71]
    v_mfma_f32_16x16x32_bf16 v[76:79], v[36:39], a[56:59], v[76:79]
    v_mfma_f32_16x16x32_bf16 v[84:87], v[36:39], a[88:91], v[84:87]
    v_mfma_f32_16x16x32_bf16 v[92:95], v[36:39], a[120:123], v[92:95]
    v_mfma_f32_16x16x32_bf16 v[88:91], v[40:43], a[124:127], v[88:91]
    v_mfma_f32_16x16x32_bf16 v[80:83], v[40:43], a[92:95], v[80:83]
    v_mfma_f32_16x16x32_bf16 v[72:75], v[40:43], a[60:63], v[72:75]
    v_mfma_f32_16x16x32_bf16 v[64:67], v[40:43], a[28:31], v[64:67]
    v_mfma_f32_16x16x32_bf16 v[68:71], v[44:47], a[28:31], v[68:71]
    v_mfma_f32_16x16x32_bf16 v[76:79], v[44:47], a[60:63], v[76:79]
    v_mfma_f32_16x16x32_bf16 v[84:87], v[44:47], a[92:95], v[84:87]
    v_mfma_f32_16x16x32_bf16 v[92:95], v[44:47], a[124:127], v[92:95]
    s_waitcnt vmcnt(4)
    s_barrier
    ds_read_b128 v[32:35], v2 offset:16384
    ds_read_b128 v[36:39], v2 offset:18432
    ds_read_b128 v[40:43], v3 offset:16384
    ds_read_b128 v[44:47], v3 offset:18432
    s_waitcnt lgkmcnt(3)
    v_mfma_f32_16x16x32_bf16 v[120:123], v[32:35], a[96:99], 0
    s_waitcnt vmcnt(0)
    v_mfma_f32_16x16x32_bf16 v[112:115], v[32:35], a[64:67], 0
    s_barrier
    v_mfma_f32_16x16x32_bf16 v[104:107], v[32:35], a[32:35], 0
    v_max3_f32 v18, v64, v65, v66
    v_max3_f32 v19, v72, v73, v74
    v_mfma_f32_16x16x32_bf16 v[96:99], v[32:35], a[0:3], 0
    s_waitcnt lgkmcnt(2)
    ds_read_b128 v[32:35], v2 offset:20480
    v_max3_f32 v20, v80, v81, v82
    v_mfma_f32_16x16x32_bf16 v[100:103], v[36:39], a[0:3], 0
    s_add_u32 m0, s21, 0
    v_max3_f32 v21, v88, v89, v90
    v_max3_f32 v18, v18, v67, v68
    v_mfma_f32_16x16x32_bf16 v[108:111], v[36:39], a[32:35], 0
    buffer_load_dwordx4 v8, s[8:11], s22 offen offset:0 lds
    v_mfma_f32_16x16x32_bf16 v[116:119], v[36:39], a[64:67], 0
    v_max3_f32 v19, v19, v75, v76
    v_max3_f32 v20, v20, v83, v84
    v_mfma_f32_16x16x32_bf16 v[124:127], v[36:39], a[96:99], 0
    s_waitcnt lgkmcnt(2)
    ds_read_b128 v[36:39], v2 offset:22528
    v_max3_f32 v21, v21, v91, v92
    v_mfma_f32_16x16x32_bf16 v[120:123], v[40:43], a[100:103], v[120:123]
    s_add_u32 m0, s21, 3968
    v_max3_f32 v18, v18, v69, v70
    v_max3_f32 v19, v19, v77, v78
    v_mfma_f32_16x16x32_bf16 v[112:115], v[40:43], a[68:71], v[112:115]
    buffer_load_dwordx4 v8, s[8:11], s22 offen offset:128 lds
    v_mfma_f32_16x16x32_bf16 v[104:107], v[40:43], a[36:39], v[104:107]
    v_max3_f32 v20, v20, v85, v86
    v_max3_f32 v21, v21, v93, v94
    v_mfma_f32_16x16x32_bf16 v[96:99], v[40:43], a[4:7], v[96:99]
    s_waitcnt lgkmcnt(2)
    ds_read_b128 v[40:43], v3 offset:20480
    v_max_f32 v18, v18, v71
    v_mfma_f32_16x16x32_bf16 v[100:103], v[44:47], a[4:7], v[100:103]
    s_add_u32 m0, s21, 7936
    v_max_f32 v19, v19, v79
    v_max_f32 v20, v20, v87
    v_mfma_f32_16x16x32_bf16 v[108:111], v[44:47], a[36:39], v[108:111]
    buffer_load_dwordx4 v8, s[8:11], s22 offen offset:256 lds
    v_mfma_f32_16x16x32_bf16 v[116:119], v[44:47], a[68:71], v[116:119]
    v_max_f32 v21, v21, v95
    v_mov_b32 v24, v18
    v_mfma_f32_16x16x32_bf16 v[124:127], v[44:47], a[100:103], v[124:127]
    s_waitcnt lgkmcnt(2)
    ds_read_b128 v[44:47], v3 offset:22528
    v_mov_b32 v25, v19
    v_mfma_f32_16x16x32_bf16 v[120:123], v[32:35], a[104:107], v[120:123]
    s_add_u32 m0, s21, 11904
    v_mov_b32 v26, v20
    v_mov_b32 v27, v21
    v_mfma_f32_16x16x32_bf16 v[112:115], v[32:35], a[72:75], v[112:115]
    buffer_load_dwordx4 v8, s[8:11], s22 offen offset:384 lds
    v_mfma_f32_16x16x32_bf16 v[104:107], v[32:35], a[40:43], v[104:107]
    v_permlane32_swap_b32 v18, v24
    v_mfma_f32_16x16x32_bf16 v[96:99], v[32:35], a[8:11], v[96:99]
    s_waitcnt lgkmcnt(2)
    ds_read_b128 v[32:35], v2 offset:24576
    v_max_f32 v18, v18, v24
    v_mfma_f32_16x16x32_bf16 v[100:103], v[36:39], a[8:11], v[100:103]
    s_add_u32 m0, s21, 49152
    v_permlane32_swap_b32 v19, v25
    v_mfma_f32_16x16x32_bf16 v[108:111], v[36:39], a[40:43], v[108:111]
    buffer_load_dwordx4 v9, s[12:15], s23 offen offset:0 lds
    v_mfma_f32_16x16x32_bf16 v[116:119], v[36:39], a[72:75], v[116:119]
    v_permlane32_swap_b32 v20, v26
    v_mfma_f32_16x16x32_bf16 v[124:127], v[36:39], a[104:107], v[124:127]
    s_waitcnt lgkmcnt(2)
    ds_read_b128 v[36:39], v2 offset:26624
    v_max_f32 v19, v19, v25
    v_mfma_f32_16x16x32_bf16 v[120:123], v[40:43], a[108:111], v[120:123]
    s_add_u32 m0, s21, 53120
    v_permlane32_swap_b32 v21, v27
    v_mfma_f32_16x16x32_bf16 v[112:115], v[40:43], a[76:79], v[112:115]
    buffer_load_dwordx4 v9, s[12:15], s23 offen offset:128 lds
    v_mfma_f32_16x16x32_bf16 v[104:107], v[40:43], a[44:47], v[104:107]
    v_max_f32 v20, v20, v26
    v_max_f32 v21, v21, v27
    v_mfma_f32_16x16x32_bf16 v[96:99], v[40:43], a[12:15], v[96:99]
    s_waitcnt lgkmcnt(2)
    ds_read_b128 v[40:43], v3 offset:24576
    v_mov_b32 v24, v18
    v_mfma_f32_16x16x32_bf16 v[100:103], v[44:47], a[12:15], v[100:103]
    s_add_u32 m0, s21, 57088
    v_mov_b32 v25, v19
    v_mov_b32 v26, v20
    v_mfma_f32_16x16x32_bf16 v[108:111], v[44:47], a[44:47], v[108:111]
    buffer_load_dwordx4 v9, s[12:15], s23 offen offset:256 lds
    v_mfma_f32_16x16x32_bf16 v[116:119], v[44:47], a[76:79], v[116:119]
    v_mov_b32 v27, v21
    v_mfma_f32_16x16x32_bf16 v[124:127], v[44:47], a[108:111], v[124:127]
    s_waitcnt lgkmcnt(2)
    ds_read_b128 v[44:47], v3 offset:26624
    v_mfma_f32_16x16x32_bf16 v[120:123], v[32:35], a[112:115], v[120:123]
    s_add_u32 m0, s21, 61056
    v_permlane16_swap_b32 v18, v24
    v_mfma_f32_16x16x32_bf16 v[112:115], v[32:35], a[80:83], v[112:115]
    buffer_load_dwordx4 v9, s[12:15], s23 offen offset:384 lds
    v_mfma_f32_16x16x32_bf16 v[104:107], v[32:35], a[48:51], v[104:107]
    s_add_u32 s22, s22, 16384
    v_permlane16_swap_b32 v19, v25
    v_mfma_f32_16x16x32_bf16 v[96:99], v[32:35], a[16:19], v[96:99]
    s_waitcnt lgkmcnt(2)
    ds_read_b128 v[32:35], v2 offset:28672
    v_max_f32 v18, v18, v24
    v_mfma_f32_16x16x32_bf16 v[100:103], v[36:39], a[16:19], v[100:103]
    s_add_u32 s23, s23, 16384
    v_permlane16_swap_b32 v20, v26
    v_mfma_f32_16x16x32_bf16 v[108:111], v[36:39], a[48:51], v[108:111]
    s_add_u32 m0, s73, 0
    v_permlane16_swap_b32 v21, v27
    v_mfma_f32_16x16x32_bf16 v[116:119], v[36:39], a[80:83], v[116:119]
    buffer_load_dwordx4 v51, s[4:7], s72 offen offset:0 nt lds
    v_mfma_f32_16x16x32_bf16 v[124:127], v[36:39], a[112:115], v[124:127]
    s_waitcnt lgkmcnt(2)
    ds_read_b128 v[36:39], v2 offset:30720
    v_max_f32 v19, v19, v25
    v_mfma_f32_16x16x32_bf16 v[120:123], v[40:43], a[116:119], v[120:123]
    s_add_u32 m0, s73, 8064
    v_max_f32 v20, v20, v26
    v_max_f32 v21, v21, v27
    v_mfma_f32_16x16x32_bf16 v[112:115], v[40:43], a[84:87], v[112:115]
    buffer_load_dwordx4 v51, s[4:7], s72 offen offset:128 nt lds
    v_mfma_f32_16x16x32_bf16 v[104:107], v[40:43], a[52:55], v[104:107]
    v_mul_f32 v18, s26, v18
    v_sub_f32 v10, 0, v18
    v_mfma_f32_16x16x32_bf16 v[96:99], v[40:43], a[20:23], v[96:99]
    s_waitcnt lgkmcnt(2)
    ds_read_b128 v[40:43], v3 offset:28672
    v_mul_f32 v19, s26, v19
    v_mfma_f32_16x16x32_bf16 v[100:103], v[44:47], a[20:23], v[100:103]
    s_add_u32 m0, s73, 16128
    v_sub_f32 v11, 0, v19
    v_mul_f32 v20, s26, v20
    v_mfma_f32_16x16x32_bf16 v[108:111], v[44:47], a[52:55], v[108:111]
    buffer_load_dwordx4 v51, s[4:7], s72 offen offset:256 nt lds
    v_mfma_f32_16x16x32_bf16 v[116:119], v[44:47], a[84:87], v[116:119]
    v_sub_f32 v12, 0, v20
    v_mul_f32 v21, s26, v21
    v_mfma_f32_16x16x32_bf16 v[124:127], v[44:47], a[116:119], v[124:127]
    s_waitcnt lgkmcnt(2)
    ds_read_b128 v[44:47], v3 offset:30720
    v_sub_f32 v13, 0, v21
    v_mfma_f32_16x16x32_bf16 v[120:123], v[32:35], a[120:123], v[120:123]
    v_fma_f32 v64, v64, s26, v10
    v_fma_f32 v65, v65, s26, v10
    v_mfma_f32_16x16x32_bf16 v[112:115], v[32:35], a[88:91], v[112:115]
    v_exp_f32 v64, v64
    v_mfma_f32_16x16x32_bf16 v[104:107], v[32:35], a[56:59], v[104:107]
    v_exp_f32 v65, v65
    v_mfma_f32_16x16x32_bf16 v[96:99], v[32:35], a[24:27], v[96:99]
    s_waitcnt lgkmcnt(2)
    ds_read_b64_tr_b16 v[32:33], v4 offset:32768
    v_fma_f32 v66, v66, s26, v10
    v_mfma_f32_16x16x32_bf16 v[100:103], v[36:39], a[24:27], v[100:103]
    ds_read_b64_tr_b16 v[34:35], v4 offset:34816
    v_fma_f32 v67, v67, s26, v10
    v_mfma_f32_16x16x32_bf16 v[108:111], v[36:39], a[56:59], v[108:111]
    v_add_f32 v18, v64, v65
    v_cvt_pk_bf16_f32 v64, v64, v65
    v_mfma_f32_16x16x32_bf16 v[116:119], v[36:39], a[88:91], v[116:119]
    v_exp_f32 v66, v66
    v_mfma_f32_16x16x32_bf16 v[124:127], v[36:39], a[120:123], v[124:127]
    s_waitcnt lgkmcnt(3)
    ds_read_b64_tr_b16 v[36:37], v5 offset:32768
    v_fma_f32 v68, v68, s26, v10
    v_mfma_f32_16x16x32_bf16 v[120:123], v[40:43], a[124:127], v[120:123]
    ds_read_b64_tr_b16 v[38:39], v5 offset:34816
    v_fma_f32 v69, v69, s26, v10
    v_mfma_f32_16x16x32_bf16 v[112:115], v[40:43], a[92:95], v[112:115]
    v_exp_f32 v67, v67
    v_mfma_f32_16x16x32_bf16 v[104:107], v[40:43], a[60:63], v[104:107]
    v_add_f32 v18, v18, v66
    v_add_f32 v18, v18, v67
    v_mfma_f32_16x16x32_bf16 v[96:99], v[40:43], a[28:31], v[96:99]
    s_waitcnt lgkmcnt(4)
    ds_read_b64_tr_b16 v[40:41], v6 offset:32768
    v_cvt_pk_bf16_f32 v65, v66, v67
    v_mfma_f32_16x16x32_bf16 v[100:103], v[44:47], a[28:31], v[100:103]
    ds_read_b64_tr_b16 v[42:43], v6 offset:34816
    v_fma_f32 v70, v70, s26, v10
    v_mfma_f32_16x16x32_bf16 v[108:111], v[44:47], a[60:63], v[108:111]
    v_exp_f32 v68, v68
    v_mfma_f32_16x16x32_bf16 v[116:119], v[44:47], a[92:95], v[116:119]
    v_exp_f32 v69, v69
    v_mfma_f32_16x16x32_bf16 v[124:127], v[44:47], a[124:127], v[124:127]
    s_waitcnt lgkmcnt(4)
    ds_read_b64_tr_b16 v[44:45], v7 offset:32768
    v_fma_f32 v71, v71, s26, v10
    v_add_f32 v18, v18, v68
    v_add_f32 v18, v18, v69
    v_cvt_pk_bf16_f32 v66, v68, v69
    v_exp_f32 v70, v70
    v_exp_f32 v71, v71
    v_fma_f32 v72, v72, s26, v11
    v_fma_f32 v73, v73, s26, v11
    v_add_f32 v18, v18, v70
    v_add_f32 v18, v18, v71
    v_cvt_pk_bf16_f32 v67, v70, v71
    v_exp_f32 v72, v72
    v_exp_f32 v73, v73
    v_fma_f32 v74, v74, s26, v11
    v_fma_f32 v75, v75, s26, v11
    v_add_f32 v19, v72, v73
    v_cvt_pk_bf16_f32 v72, v72, v73
    v_exp_f32 v74, v74
    v_exp_f32 v75, v75
    v_fma_f32 v76, v76, s26, v11
    v_fma_f32 v77, v77, s26, v11
    v_add_f32 v19, v19, v74
    v_add_f32 v19, v19, v75
    v_cvt_pk_bf16_f32 v73, v74, v75
    v_exp_f32 v76, v76
    v_exp_f32 v77, v77
    v_fma_f32 v78, v78, s26, v11
    v_fma_f32 v79, v79, s26, v11
    v_add_f32 v19, v19, v76
    v_add_f32 v19, v19, v77
    v_cvt_pk_bf16_f32 v74, v76, v77
    v_exp_f32 v78, v78
    v_exp_f32 v79, v79
    v_fma_f32 v80, v80, s26, v12
    v_fma_f32 v81, v81, s26, v12
    v_add_f32 v19, v19, v78
    v_add_f32 v19, v19, v79
    v_cvt_pk_bf16_f32 v75, v78, v79
    v_exp_f32 v80, v80
    v_exp_f32 v81, v81
    v_fma_f32 v82, v82, s26, v12
    v_fma_f32 v83, v83, s26, v12
    v_add_f32 v20, v80, v81
    v_cvt_pk_bf16_f32 v80, v80, v81
    v_exp_f32 v82, v82
    v_exp_f32 v83, v83
    v_fma_f32 v84, v84, s26, v12
    v_fma_f32 v85, v85, s26, v12
    v_add_f32 v20, v20, v82
    v_add_f32 v20, v20, v83
    v_cvt_pk_bf16_f32 v81, v82, v83
    v_exp_f32 v84, v84
    v_exp_f32 v85, v85
    v_fma_f32 v86, v86, s26, v12
    v_fma_f32 v87, v87, s26, v12
    v_add_f32 v20, v20, v84
    v_add_f32 v20, v20, v85
    v_cvt_pk_bf16_f32 v82, v84, v85
    v_exp_f32 v86, v86
    v_exp_f32 v87, v87
    v_fma_f32 v88, v88, s26, v13
    v_fma_f32 v89, v89, s26, v13
    v_add_f32 v20, v20, v86
    v_add_f32 v20, v20, v87
    v_cvt_pk_bf16_f32 v83, v86, v87
    v_exp_f32 v88, v88
    v_exp_f32 v89, v89
    v_fma_f32 v90, v90, s26, v13
    v_fma_f32 v91, v91, s26, v13
    v_add_f32 v21, v88, v89
    v_cvt_pk_bf16_f32 v88, v88, v89
    v_exp_f32 v90, v90
    v_exp_f32 v91, v91
    v_fma_f32 v92, v92, s26, v13
    v_fma_f32 v93, v93, s26, v13
    v_add_f32 v21, v21, v90
    v_add_f32 v21, v21, v91
    v_cvt_pk_bf16_f32 v89, v90, v91
    v_exp_f32 v92, v92
    v_exp_f32 v93, v93
    v_fma_f32 v94, v94, s26, v13
    v_fma_f32 v95, v95, s26, v13
    v_add_f32 v21, v21, v92
    v_add_f32 v21, v21, v93
    v_cvt_pk_bf16_f32 v90, v92, v93
    v_exp_f32 v94, v94
    v_exp_f32 v95, v95
    v_add_f32 v21, v21, v94
    v_add_f32 v21, v21, v95
    v_cvt_pk_bf16_f32 v91, v94, v95
    v_mov_b32 v14, v18
    v_mov_b32 v15, v19
    v_mov_b32 v16, v20
    v_mov_b32 v17, v21
    s_add_u32 s72, s72, 4096
    s_add_u32 s73, s73, 1024
    v_xor_b32 v51, 64, v51
    s_add_u32 s29, s29, 16384
    v_mfma_f32_16x16x32_bf16 v[128:131], v[32:35], v[64:67], 0
    ds_read_b64_tr_b16 v[46:47], v7 offset:34816
    v_fma_f32 v96, v96, s26, v10
    v_mfma_f32_16x16x32_bf16 v[192:195], v[32:35], v[72:75], 0
    s_waitcnt vmcnt(7)
    v_fma_f32 v97, v97, s26, v10
    v_mfma_f32_16x16x32_bf16 a[128:131], v[32:35], v[80:83], 0
    s_barrier
    v_mfma_f32_16x16x32_bf16 a[192:195], v[32:35], v[88:91], 0
    s_waitcnt lgkmcnt(4)
    ds_read_b64_tr_b16 v[32:33], v4 offset:36864
    v_mfma_f32_16x16x32_bf16 a[196:199], v[36:39], v[88:91], 0
    ds_read_b64_tr_b16 v[34:35], v4 offset:38912
    v_fma_f32 v98, v98, s26, v10
    v_mfma_f32_16x16x32_bf16 a[132:135], v[36:39], v[80:83], 0
    s_add_u32 m0, s21, 16384
    v_exp_f32 v96, v96
    v_mfma_f32_16x16x32_bf16 v[196:199], v[36:39], v[72:75], 0
    buffer_load_dwordx4 v8, s[8:11], s22 offen offset:0 lds
    v_mfma_f32_16x16x32_bf16 v[132:135], v[36:39], v[64:67], 0
    s_waitcnt lgkmcnt(4)
    ds_read_b64_tr_b16 v[36:37], v5 offset:36864
    v_fma_f32 v99, v99, s26, v10
    v_mfma_f32_16x16x32_bf16 v[136:139], v[40:43], v[64:67], 0
    ds_read_b64_tr_b16 v[38:39], v5 offset:38912
    v_mfma_f32_16x16x32_bf16 v[200:203], v[40:43], v[72:75], 0
    s_add_u32 m0, s21, 20352
    v_exp_f32 v97, v97
    v_mfma_f32_16x16x32_bf16 a[136:139], v[40:43], v[80:83], 0
    buffer_load_dwordx4 v8, s[8:11], s22 offen offset:128 lds
    v_mfma_f32_16x16x32_bf16 a[200:203], v[40:43], v[88:91], 0
    s_waitcnt lgkmcnt(4)
    ds_read_b64_tr_b16 v[40:41], v6 offset:36864
    v_add_f32 v18, v96, v97
    v_mfma_f32_16x16x32_bf16 a[204:207], v[44:47], v[88:91], 0
    ds_read_b64_tr_b16 v[42:43], v6 offset:38912
    v_cvt_pk_bf16_f32 v96, v96, v97
    v_mfma_f32_16x16x32_bf16 a[140:143], v[44:47], v[80:83], 0
    s_add_u32 m0, s21, 24320
    v_exp_f32 v98, v98
    v_mfma_f32_16x16x32_bf16 v[204:207], v[44:47], v[72:75], 0
    buffer_load_dwordx4 v8, s[8:11], s22 offen offset:256 lds
    v_mfma_f32_16x16x32_bf16 v[140:143], v[44:47], v[64:67], 0
    s_waitcnt lgkmcnt(4)
    ds_read_b64_tr_b16 v[44:45], v7 offset:36864
    v_fma_f32 v100, v100, s26, v10
    v_mfma_f32_16x16x32_bf16 v[144:147], v[32:35], v[64:67], 0
    ds_read_b64_tr_b16 v[46:47], v7 offset:38912
    v_fma_f32 v101, v101, s26, v10
    v_mfma_f32_16x16x32_bf16 v[208:211], v[32:35], v[72:75], 0
    s_add_u32 m0, s21, 28288
    v_exp_f32 v99, v99
    v_mfma_f32_16x16x32_bf16 a[144:147], v[32:35], v[80:83], 0
    buffer_load_dwordx4 v8, s[8:11], s22 offen offset:384 lds
    v_mfma_f32_16x16x32_bf16 a[208:211], v[32:35], v[88:91], 0
    s_waitcnt lgkmcnt(4)
    ds_read_b64_tr_b16 v[32:33], v4 offset:40960
    v_add_f32 v18, v18, v98
    v_mfma_f32_16x16x32_bf16 a[212:215], v[36:39], v[88:91], 0
    s_add_u32 s22, s22, 16384
    ds_read_b64_tr_b16 v[34:35], v4 offset:43008
    v_add_f32 v18, v18, v99
    v_mfma_f32_16x16x32_bf16 a[148:151], v[36:39], v[80:83], 0
    s_cmp_eq_u32 s22, s30
    s_cselect_b32 s22, s31, s22
    v_cvt_pk_bf16_f32 v97, v98, v99
    v_mfma_f32_16x16x32_bf16 v[212:215], v[36:39], v[72:75], 0
    v_exp_f32 v100, v100
    v_mfma_f32_16x16x32_bf16 v[148:151], v[36:39], v[64:67], 0
    s_waitcnt lgkmcnt(4)
    ds_read_b64_tr_b16 v[36:37], v5 offset:40960
    v_fma_f32 v102, v102, s26, v10
    v_mfma_f32_16x16x32_bf16 v[152:155], v[40:43], v[64:67], 0
    ds_read_b64_tr_b16 v[38:39], v5 offset:43008
    v_fma_f32 v103, v103, s26, v10
    v_mfma_f32_16x16x32_bf16 v[216:219], v[40:43], v[72:75], 0
    v_exp_f32 v101, v101
    v_mfma_f32_16x16x32_bf16 a[152:155], v[40:43], v[80:83], 0
    v_add_f32 v18, v18, v100
    v_add_f32 v18, v18, v101
    v_mfma_f32_16x16x32_bf16 a[216:219], v[40:43], v[88:91], 0
    s_waitcnt lgkmcnt(4)
    ds_read_b64_tr_b16 v[40:41], v6 offset:40960
    v_cvt_pk_bf16_f32 v98, v100, v101
    v_mfma_f32_16x16x32_bf16 a[220:223], v[44:47], v[88:91], 0
    ds_read_b64_tr_b16 v[42:43], v6 offset:43008
    v_fma_f32 v104, v104, s26, v11
    v_mfma_f32_16x16x32_bf16 a[156:159], v[44:47], v[80:83], 0
    v_exp_f32 v102, v102
    v_mfma_f32_16x16x32_bf16 v[220:223], v[44:47], v[72:75], 0
    v_exp_f32 v103, v103
    v_mfma_f32_16x16x32_bf16 v[156:159], v[44:47], v[64:67], 0
    s_waitcnt lgkmcnt(4)
    ds_read_b64_tr_b16 v[44:45], v7 offset:40960
    v_fma_f32 v105, v105, s26, v11
    v_mfma_f32_16x16x32_bf16 v[160:163], v[32:35], v[64:67], 0
    ds_read_b64_tr_b16 v[46:47], v7 offset:43008
    v_add_f32 v18, v18, v102
    v_mfma_f32_16x16x32_bf16 v[224:227], v[32:35], v[72:75], 0
    v_add_f32 v18, v18, v103
    v_cvt_pk_bf16_f32 v99, v102, v103
    v_mfma_f32_16x16x32_bf16 a[160:163], v[32:35], v[80:83], 0
    v_exp_f32 v104, v104
    v_mfma_f32_16x16x32_bf16 a[224:227], v[32:35], v[88:91], 0
    s_waitcnt lgkmcnt(4)
    ds_read_b64_tr_b16 v[32:33], v4 offset:45056
    v_fma_f32 v106, v106, s26, v11
    v_mfma_f32_16x16x32_bf16 a[228:231], v[36:39], v[88:91], 0
    ds_read_b64_tr_b16 v[34:35], v4 offset:47104
    v_fma_f32 v107, v107, s26, v11
    v_mfma_f32_16x16x32_bf16 a[164:167], v[36:39], v[80:83], 0
    v_exp_f32 v105, v105
    v_mfma_f32_16x16x32_bf16 v[228:231], v[36:39], v[72:75], 0
    v_add_f32 v19, v104, v105
    v_cvt_pk_bf16_f32 v104, v104, v105
    v_mfma_f32_16x16x32_bf16 v[164:167], v[36:39], v[64:67], 0
    s_waitcnt lgkmcnt(4)
    ds_read_b64_tr_b16 v[36:37], v5 offset:45056
    v_fma_f32 v108, v108, s26, v11
    v_mfma_f32_16x16x32_bf16 v[168:171], v[40:43], v[64:67], 0
    ds_read_b64_tr_b16 v[38:39], v5 offset:47104
    v_fma_f32 v109, v109, s26, v11
    v_mfma_f32_16x16x32_bf16 v[232:235], v[40:43], v[72:75], 0
    v_exp_f32 v106, v106
    v_mfma_f32_16x16x32_bf16 a[168:171], v[40:43], v[80:83], 0
    v_exp_f32 v107, v107
    v_mfma_f32_16x16x32_bf16 a[232:235], v[40:43], v[88:91], 0
    s_waitcnt lgkmcnt(4)
    ds_read_b64_tr_b16 v[40:41], v6 offset:45056
    v_add_f32 v19, v19, v106
    v_mfma_f32_16x16x32_bf16 a[236:239], v[44:47], v[88:91], 0
    ds_read_b64_tr_b16 v[42:43], v6 offset:47104
    v_add_f32 v19, v19, v107
    v_mfma_f32_16x16x32_bf16 a[172:175], v[44:47], v[80:83], 0
    v_cvt_pk_bf16_f32 v105, v106, v107
    v_mfma_f32_16x16x32_bf16 v[236:239], v[44:47], v[72:75], 0
    v_exp_f32 v108, v108
    v_mfma_f32_16x16x32_bf16 v[172:175], v[44:47], v[64:67], 0
    s_waitcnt lgkmcnt(4)
    ds_read_b64_tr_b16 v[44:45], v7 offset:45056
    v_fma_f32 v110, v110, s26, v11
    v_mfma_f32_16x16x32_bf16 v[176:179], v[32:35], v[64:67], 0
    ds_read_b64_tr_b16 v[46:47], v7 offset:47104
    v_fma_f32 v111, v111, s26, v11
    v_mfma_f32_16x16x32_bf16 v[240:243], v[32:35], v[72:75], 0
    v_exp_f32 v109, v109
    v_mfma_f32_16x16x32_bf16 a[176:179], v[32:35], v[80:83], 0
    v_add_f32 v19, v19, v108
    v_add_f32 v19, v19, v109
    v_mfma_f32_16x16x32_bf16 a[240:243], v[32:35], v[88:91], 0
    s_waitcnt lgkmcnt(4)
    ds_read_b128 v[32:35], v2 offset:0
    v_cvt_pk_bf16_f32 v106, v108, v109
    v_mfma_f32_16x16x32_bf16 a[244:247], v[36:39], v[88:91], 0
    v_exp_f32 v110, v110
    v_mfma_f32_16x16x32_bf16 a[180:183], v[36:39], v[80:83], 0
    v_exp_f32 v111, v111
    v_mfma_f32_16x16x32_bf16 v[244:247], v[36:39], v[72:75], 0
    v_fma_f32 v112, v112, s26, v12
    v_mfma_f32_16x16x32_bf16 v[180:183], v[36:39], v[64:67], 0
    s_waitcnt lgkmcnt(3)
    ds_read_b128 v[36:39], v2 offset:2048
    v_fma_f32 v113, v113, s26, v12
    v_mfma_f32_16x16x32_bf16 v[184:187], v[40:43], v[64:67], 0
    v_add_f32 v19, v19, v110
    v_mfma_f32_16x16x32_bf16 v[248:251], v[40:43], v[72:75], 0
    v_mfma_f32_16x16x32_bf16 a[184:187], v[40:43], v[80:83], 0
    v_add_f32 v19, v19, v111
    v_mfma_f32_16x16x32_bf16 a[248:251], v[40:43], v[88:91], 0
    s_waitcnt lgkmcnt(2)
    ds_read_b128 v[40:43], v3 offset:0
    v_cvt_pk_bf16_f32 v107, v110, v111
    v_mfma_f32_16x16x32_bf16 a[252:255], v[44:47], v[88:91], 0
    v_exp_f32 v112, v112
    v_mfma_f32_16x16x32_bf16 a[188:191], v[44:47], v[80:83], 0
    v_exp_f32 v113, v113
    v_mfma_f32_16x16x32_bf16 v[252:255], v[44:47], v[72:75], 0
    v_fma_f32 v114, v114, s26, v12
    v_mfma_f32_16x16x32_bf16 v[188:191], v[44:47], v[64:67], 0
    s_waitcnt lgkmcnt(2)
    ds_read_b128 v[44:47], v3 offset:2048
    s_mov_b32 s24, 7
.p2align 6
L_loop0:
    v_mfma_f32_16x16x32_bf16 v[88:91], v[32:35], a[96:99], 0
    s_waitcnt vmcnt(4)
    v_fma_f32 v115, v115, s26, v12
    v_add_f32 v20, v112, v113
    v_mfma_f32_16x16x32_bf16 v[80:83], v[32:35], a[64:67], 0
    s_barrier
    v_mfma_f32_16x16x32_bf16 v[72:75], v[32:35], a[32:35], 0
    v_cvt_pk_bf16_f32 v112, v112, v113
    v_mfma_f32_16x16x32_bf16 v[64:67], v[32:35], a[0:3], 0
    s_waitcnt lgkmcnt(2)
    ds_read_b128 v[32:35], v2 offset:4096
    v_mfma_f32_16x16x32_bf16 v[68:71], v[36:39], a[0:3], 0
    s_add_u32 m0, s21, 32768
    v_exp_f32 v114, v114
    v_mfma_f32_16x16x32_bf16 v[76:79], v[36:39], a[32:35], 0
    buffer_load_dwordx4 v9, s[12:15], s23 offen offset:0 lds
    v_mfma_f32_16x16x32_bf16 v[84:87], v[36:39], a[64:67], 0
    v_exp_f32 v115, v115
    v_mfma_f32_16x16x32_bf16 v[92:95], v[36:39], a[96:99], 0
    s_waitcnt lgkmcnt(2)
    ds_read_b128 v[36:39], v2 offset:6144
    v_fma_f32 v116, v116, s26, v12
    v_mfma_f32_16x16x32_bf16 v[88:91], v[40:43], a[100:103], v[88:91]
    s_add_u32 m0, s21, 36736
    v_fma_f32 v117, v117, s26, v12
    v_add_f32 v20, v20, v114
    v_mfma_f32_16x16x32_bf16 v[80:83], v[40:43], a[68:71], v[80:83]
    buffer_load_dwordx4 v9, s[12:15], s23 offen offset:128 lds
    v_mfma_f32_16x16x32_bf16 v[72:75], v[40:43], a[36:39], v[72:75]
    v_add_f32 v20, v20, v115
    v_cvt_pk_bf16_f32 v113, v114, v115
    v_mfma_f32_16x16x32_bf16 v[64:67], v[40:43], a[4:7], v[64:67]
    s_waitcnt lgkmcnt(2)
    ds_read_b128 v[40:43], v3 offset:4096
    v_mfma_f32_16x16x32_bf16 v[68:71], v[44:47], a[4:7], v[68:71]
    s_add_u32 m0, s21, 40704
    v_exp_f32 v116, v116
    v_mfma_f32_16x16x32_bf16 v[76:79], v[44:47], a[36:39], v[76:79]
    buffer_load_dwordx4 v9, s[12:15], s23 offen offset:256 lds
    v_mfma_f32_16x16x32_bf16 v[84:87], v[44:47], a[68:71], v[84:87]
    v_exp_f32 v117, v117
    v_mfma_f32_16x16x32_bf16 v[92:95], v[44:47], a[100:103], v[92:95]
    s_waitcnt lgkmcnt(2)
    ds_read_b128 v[44:47], v3 offset:6144
    v_fma_f32 v118, v118, s26, v12
    v_mfma_f32_16x16x32_bf16 v[88:91], v[32:35], a[104:107], v[88:91]
    s_add_u32 m0, s21, 44672
    v_fma_f32 v119, v119, s26, v12
    v_add_f32 v20, v20, v116
    v_mfma_f32_16x16x32_bf16 v[80:83], v[32:35], a[72:75], v[80:83]
    buffer_load_dwordx4 v9, s[12:15], s23 offen offset:384 lds
    v_mfma_f32_16x16x32_bf16 v[72:75], v[32:35], a[40:43], v[72:75]
    s_add_u32 s23, s23, 16384
    v_add_f32 v20, v20, v117
    v_cvt_pk_bf16_f32 v114, v116, v117
    v_mfma_f32_16x16x32_bf16 v[64:67], v[32:35], a[8:11], v[64:67]
    s_waitcnt lgkmcnt(2)
    ds_read_b128 v[32:35], v2 offset:8192
    v_fma_f32 v120, v120, s26, v13
    v_mfma_f32_16x16x32_bf16 v[68:71], v[36:39], a[8:11], v[68:71]
    s_cmp_eq_u32 s23, s30
    s_cselect_b32 s23, s31, s23
    v_fma_f32 v121, v121, s26, v13
    v_mfma_f32_16x16x32_bf16 v[76:79], v[36:39], a[40:43], v[76:79]
    v_exp_f32 v118, v118
    v_mfma_f32_16x16x32_bf16 v[84:87], v[36:39], a[72:75], v[84:87]
    v_exp_f32 v119, v119
    v_mfma_f32_16x16x32_bf16 v[92:95], v[36:39], a[104:107], v[92:95]
    s_waitcnt lgkmcnt(2)
    ds_read_b128 v[36:39], v2 offset:10240
    v_add_f32 v20, v20, v118
    v_mfma_f32_16x16x32_bf16 v[88:91], v[40:43], a[108:111], v[88:91]
    s_add_u32 m0, s73, 0
    v_add_f32 v20, v20, v119
    v_cvt_pk_bf16_f32 v115, v118, v119
    v_mfma_f32_16x16x32_bf16 v[80:83], v[40:43], a[76:79], v[80:83]
    buffer_load_dwordx4 v51, s[4:7], s72 offen offset:0 nt lds
    v_mfma_f32_16x16x32_bf16 v[72:75], v[40:43], a[44:47], v[72:75]
    v_exp_f32 v120, v120
    v_mfma_f32_16x16x32_bf16 v[64:67], v[40:43], a[12:15], v[64:67]
    s_waitcnt lgkmcnt(2)
    ds_read_b128 v[40:43], v3 offset:8192
    v_fma_f32 v122, v122, s26, v13
    v_mfma_f32_16x16x32_bf16 v[68:71], v[44:47], a[12:15], v[68:71]
    s_add_u32 m0, s73, 8064
    v_exp_f32 v121, v121
    v_mfma_f32_16x16x32_bf16 v[76:79], v[44:47], a[44:47], v[76:79]
    buffer_load_dwordx4 v51, s[4:7], s72 offen offset:128 nt lds
    v_mfma_f32_16x16x32_bf16 v[84:87], v[44:47], a[76:79], v[84:87]
    v_fma_f32 v123, v123, s26, v13
    v_add_f32 v21, v120, v121
    v_mfma_f32_16x16x32_bf16 v[92:95], v[44:47], a[108:111], v[92:95]
    s_waitcnt lgkmcnt(2)
    ds_read_b128 v[44:47], v3 offset:10240
    v_cvt_pk_bf16_f32 v120, v120, v121
    v_mfma_f32_16x16x32_bf16 v[88:91], v[32:35], a[112:115], v[88:91]
    s_add_u32 m0, s73, 16128
    v_exp_f32 v122, v122
    v_mfma_f32_16x16x32_bf16 v[80:83], v[32:35], a[80:83], v[80:83]
    buffer_load_dwordx4 v51, s[4:7], s72 offen offset:256 nt lds
    v_mfma_f32_16x16x32_bf16 v[72:75], v[32:35], a[48:51], v[72:75]
    s_add_u32 s72, s72, 4096
    v_xor_b32 v51, 64, v51
    v_fma_f32 v124, v124, s26, v13
    v_mfma_f32_16x16x32_bf16 v[64:67], v[32:35], a[16:19], v[64:67]
    s_waitcnt lgkmcnt(2)
    ds_read_b128 v[32:35], v2 offset:12288
    v_fma_f32 v125, v125, s26, v13
    v_mfma_f32_16x16x32_bf16 v[68:71], v[36:39], a[16:19], v[68:71]
    s_add_u32 s73, s73, 1024
    v_exp_f32 v123, v123
    v_mfma_f32_16x16x32_bf16 v[76:79], v[36:39], a[48:51], v[76:79]
    v_add_f32 v21, v21, v122
    v_add_f32 v21, v21, v123
    v_mfma_f32_16x16x32_bf16 v[84:87], v[36:39], a[80:83], v[84:87]
    v_cvt_pk_bf16_f32 v121, v122, v123
    v_mfma_f32_16x16x32_bf16 v[92:95], v[36:39], a[112:115], v[92:95]
    s_waitcnt lgkmcnt(2)
    ds_read_b128 v[36:39], v2 offset:14336
    v_mfma_f32_16x16x32_bf16 v[88:91], v[40:43], a[116:119], v[88:91]
    v_exp_f32 v124, v124
    v_mfma_f32_16x16x32_bf16 v[80:83], v[40:43], a[84:87], v[80:83]
    v_exp_f32 v125, v125
    v_mfma_f32_16x16x32_bf16 v[72:75], v[40:43], a[52:55], v[72:75]
    v_fma_f32 v126, v126, s26, v13
    v_fma_f32 v127, v127, s26, v13
    v_mfma_f32_16x16x32_bf16 v[64:67], v[40:43], a[20:23], v[64:67]
    s_waitcnt lgkmcnt(2)
    ds_read_b128 v[40:43], v3 offset:12288
    v_add_f32 v21, v21, v124
    v_mfma_f32_16x16x32_bf16 v[68:71], v[44:47], a[20:23], v[68:71]
    v_add_f32 v21, v21, v125
    v_add_f32 v22, v18, v19
    v_mfma_f32_16x16x32_bf16 v[76:79], v[44:47], a[52:55], v[76:79]
    v_cvt_pk_bf16_f32 v122, v124, v125
    v_mfma_f32_16x16x32_bf16 v[84:87], v[44:47], a[84:87], v[84:87]
    v_exp_f32 v126, v126
    v_mfma_f32_16x16x32_bf16 v[92:95], v[44:47], a[116:119], v[92:95]
    s_waitcnt lgkmcnt(2)
    ds_read_b128 v[44:47], v3 offset:14336
    v_mfma_f32_16x16x32_bf16 v[88:91], v[32:35], a[120:123], v[88:91]
    v_exp_f32 v127, v127
    v_mfma_f32_16x16x32_bf16 v[80:83], v[32:35], a[88:91], v[80:83]
    v_add_f32 v21, v21, v126
    v_add_f32 v21, v21, v127
    v_mfma_f32_16x16x32_bf16 v[72:75], v[32:35], a[56:59], v[72:75]
    v_cvt_pk_bf16_f32 v123, v126, v127
    v_add_f32 v23, v20, v21
    v_mfma_f32_16x16x32_bf16 v[64:67], v[32:35], a[24:27], v[64:67]
    s_waitcnt lgkmcnt(2)
    ds_read_b64_tr_b16 v[32:33], v4 offset:49152
    v_add_f32 v22, v22, v23
    v_mfma_f32_16x16x32_bf16 v[68:71], v[36:39], a[24:27], v[68:71]
    ds_read_b64_tr_b16 v[34:35], v4 offset:51200
    v_cmp_nge_f32 vcc, s27, v22
    v_mfma_f32_16x16x32_bf16 v[76:79], v[36:39], a[56:59], v[76:79]
    v_mfma_f32_16x16x32_bf16 v[84:87], v[36:39], a[88:91], v[84:87]
    s_cbranch_vccnz L_stub_it0a
L_ret_it0a:
    v_mfma_f32_16x16x32_bf16 v[92:95], v[36:39], a[120:123], v[92:95]
    s_waitcnt lgkmcnt(3)
    ds_read_b64_tr_b16 v[36:37], v5 offset:49152
    v_add_f32 v14, v14, v18
    v_mfma_f32_16x16x32_bf16 v[88:91], v[40:43], a[124:127], v[88:91]
    s_add_u32 s29, s29, 16384
    ds_read_b64_tr_b16 v[38:39], v5 offset:51200
    v_add_f32 v15, v15, v19
    v_mfma_f32_16x16x32_bf16 v[80:83], v[40:43], a[92:95], v[80:83]
    v_add_f32 v16, v16, v20
    v_add_f32 v17, v17, v21
    v_mfma_f32_16x16x32_bf16 v[72:75], v[40:43], a[60:63], v[72:75]
    v_mfma_f32_16x16x32_bf16 v[64:67], v[40:43], a[28:31], v[64:67]
    s_waitcnt lgkmcnt(4)
    ds_read_b64_tr_b16 v[40:41], v6 offset:49152
    v_mfma_f32_16x16x32_bf16 v[68:71], v[44:47], a[28:31], v[68:71]
    ds_read_b64_tr_b16 v[42:43], v6 offset:51200
    v_mfma_f32_16x16x32_bf16 v[76:79], v[44:47], a[60:63], v[76:79]
    v_mfma_f32_16x16x32_bf16 v[84:87], v[44:47], a[92:95], v[84:87]
    v_mfma_f32_16x16x32_bf16 v[92:95], v[44:47], a[124:127], v[92:95]
    s_waitcnt lgkmcnt(4)
    ds_read_b64_tr_b16 v[44:45], v7 offset:49152
    v_mfma_f32_16x16x32_bf16 v[128:131], v[32:35], v[96:99], v[128:131]
    ds_read_b64_tr_b16 v[46:47], v7 offset:51200
    v_fma_f32 v64, v64, s26, v10
    v_mfma_f32_16x16x32_bf16 v[192:195], v[32:35], v[104:107], v[192:195]
    s_waitcnt vmcnt(7)
    v_fma_f32 v65, v65, s26, v10
    v_mfma_f32_16x16x32_bf16 a[128:131], v[32:35], v[112:115], a[128:131]
    s_barrier
    v_mfma_f32_16x16x32_bf16 a[192:195], v[32:35], v[120:123], a[192:195]
    s_waitcnt lgkmcnt(4)
    ds_read_b64_tr_b16 v[32:33], v4 offset:53248
    v_mfma_f32_16x16x32_bf16 a[196:199], v[36:39], v[120:123], a[196:199]
    ds_read_b64_tr_b16 v[34:35], v4 offset:55296
    v_fma_f32 v66, v66, s26, v10
    v_mfma_f32_16x16x32_bf16 a[132:135], v[36:39], v[112:115], a[132:135]
    s_add_u32 m0, s21, 0
    v_exp_f32 v64, v64
    v_mfma_f32_16x16x32_bf16 v[196:199], v[36:39], v[104:107], v[196:199]
    buffer_load_dwordx4 v8, s[8:11], s22 offen offset:0 lds
    v_mfma_f32_16x16x32_bf16 v[132:135], v[36:39], v[96:99], v[132:135]
    s_waitcnt lgkmcnt(4)
    ds_read_b64_tr_b16 v[36:37], v5 offset:53248
    v_fma_f32 v67, v67, s26, v10
    v_mfma_f32_16x16x32_bf16 v[136:139], v[40:43], v[96:99], v[136:139]
    ds_read_b64_tr_b16 v[38:39], v5 offset:55296
    v_mfma_f32_16x16x32_bf16 v[200:203], v[40:43], v[104:107], v[200:203]
    s_add_u32 m0, s21, 3968
    v_exp_f32 v65, v65
    v_mfma_f32_16x16x32_bf16 a[136:139], v[40:43], v[112:115], a[136:139]
    buffer_load_dwordx4 v8, s[8:11], s22 offen offset:128 lds
    v_mfma_f32_16x16x32_bf16 a[200:203], v[40:43], v[120:123], a[200:203]
    s_waitcnt lgkmcnt(4)
    ds_read_b64_tr_b16 v[40:41], v6 offset:53248
    v_add_f32 v18, v64, v65
    v_mfma_f32_16x16x32_bf16 a[204:207], v[44:47], v[120:123], a[204:207]
    ds_read_b64_tr_b16 v[42:43], v6 offset:55296
    v_cvt_pk_bf16_f32 v64, v64, v65
    v_mfma_f32_16x16x32_bf16 a[140:143], v[44:47], v[112:115], a[140:143]
    s_add_u32 m0, s21, 7936
    v_exp_f32 v66, v66
    v_mfma_f32_16x16x32_bf16 v[204:207], v[44:47], v[104:107], v[204:207]
    buffer_load_dwordx4 v8, s[8:11], s22 offen offset:256 lds
    v_mfma_f32_16x16x32_bf16 v[140:143], v[44:47], v[96:99], v[140:143]
    s_waitcnt lgkmcnt(4)
    ds_read_b64_tr_b16 v[44:45], v7 offset:53248
    v_fma_f32 v68, v68, s26, v10
    v_mfma_f32_16x16x32_bf16 v[144:147], v[32:35], v[96:99], v[144:147]
    ds_read_b64_tr_b16 v[46:47], v7 offset:55296
    v_fma_f32 v69, v69, s26, v10
    v_mfma_f32_16x16x32_bf16 v[208:211], v[32:35], v[104:107], v[208:211]
    s_add_u32 m0, s21, 11904
    v_exp_f32 v67, v67
    v_mfma_f32_16x16x32_bf16 a[144:147], v[32:35], v[112:115], a[144:147]
    buffer_load_dwordx4 v8, s[8:11], s22 offen offset:384 lds
    v_mfma_f32_16x16x32_bf16 a[208:211], v[32:35], v[120:123], a[208:211]
    s_waitcnt lgkmcnt(4)
    ds_read_b64_tr_b16 v[32:33], v4 offset:57344
    v_add_f32 v18, v18, v66
    v_mfma_f32_16x16x32_bf16 a[212:215], v[36:39], v[120:123], a[212:215]
    s_add_u32 s22, s22, 16384
    ds_read_b64_tr_b16 v[34:35], v4 offset:59392
    v_add_f32 v18, v18, v67
    v_mfma_f32_16x16x32_bf16 a[148:151], v[36:39], v[112:115], a[148:151]
    s_cmp_eq_u32 s22, s30
    s_cselect_b32 s22, s31, s22
    v_cvt_pk_bf16_f32 v65, v66, v67
    v_mfma_f32_16x16x32_bf16 v[212:215], v[36:39], v[104:107], v[212:215]
    v_exp_f32 v68, v68
    v_mfma_f32_16x16x32_bf16 v[148:151], v[36:39], v[96:99], v[148:151]
    s_waitcnt lgkmcnt(4)
    ds_read_b64_tr_b16 v[36:37], v5 offset:57344
    v_fma_f32 v70, v70, s26, v10
    v_mfma_f32_16x16x32_bf16 v[152:155], v[40:43], v[96:99], v[152:155]
    ds_read_b64_tr_b16 v[38:39], v5 offset:59392
    v_fma_f32 v71, v71, s26, v10
    v_mfma_f32_16x16x32_bf16 v[216:219], v[40:43], v[104:107], v[216:219]
    v_exp_f32 v69, v69
    v_mfma_f32_16x16x32_bf16 a[152:155], v[40:43], v[112:115], a[152:155]
    v_add_f32 v18, v18, v68
    v_add_f32 v18, v18, v69
    v_mfma_f32_16x16x32_bf16 a[216:219], v[40:43], v[120:123], a[216:219]
    s_waitcnt lgkmcnt(4)
    ds_read_b64_tr_b16 v[40:41], v6 offset:57344
    v_cvt_pk_bf16_f32 v66, v68, v69
    v_mfma_f32_16x16x32_bf16 a[220:223], v[44:47], v[120:123], a[220:223]
    ds_read_b64_tr_b16 v[42:43], v6 offset:59392
    v_fma_f32 v72, v72, s26, v11
    v_mfma_f32_16x16x32_bf16 a[156:159], v[44:47], v[112:115], a[156:159]
    v_exp_f32 v70, v70
    v_mfma_f32_16x16x32_bf16 v[220:223], v[44:47], v[104:107], v[220:223]
    v_exp_f32 v71, v71
    v_mfma_f32_16x16x32_bf16 v[156:159], v[44:47], v[96:99], v[156:159]
    s_waitcnt lgkmcnt(4)
    ds_read_b64_tr_b16 v[44:45], v7 offset:57344
    v_fma_f32 v73, v73, s26, v11
    v_mfma_f32_16x16x32_bf16 v[160:163], v[32:35], v[96:99], v[160:163]
    ds_read_b64_tr_b16 v[46:47], v7 offset:59392
    v_add_f32 v18, v18, v70
    v_mfma_f32_16x16x32_bf16 v[224:227], v[32:35], v[104:107], v[224:227]
    v_add_f32 v18, v18, v71
    v_cvt_pk_bf16_f32 v67, v70, v71
    v_mfma_f32_16x16x32_bf16 a[160:163], v[32:35], v[112:115], a[160:163]
    v_exp_f32 v72, v72
    v_mfma_f32_16x16x32_bf16 a[224:227], v[32:35], v[120:123], a[224:227]
    s_waitcnt lgkmcnt(4)
    ds_read_b64_tr_b16 v[32:33], v4 offset:61440
    v_fma_f32 v74, v74, s26, v11
    v_mfma_f32_16x16x32_bf16 a[228:231], v[36:39], v[120:123], a[228:231]
    ds_read_b64_tr_b16 v[34:35], v4 offset:63488
    v_fma_f32 v75, v75, s26, v11
    v_mfma_f32_16x16x32_bf16 a[164:167], v[36:39], v[112:115], a[164:167]
    v_exp_f32 v73, v73
    v_mfma_f32_16x16x32_bf16 v[228:231], v[36:39], v[104:107], v[228:231]
    v_add_f32 v19, v72, v73
    v_cvt_pk_bf16_f32 v72, v72, v73
    v_mfma_f32_16x16x32_bf16 v[164:167], v[36:39], v[96:99], v[164:167]
    s_waitcnt lgkmcnt(4)
    ds_read_b64_tr_b16 v[36:37], v5 offset:61440
    v_fma_f32 v76, v76, s26, v11
    v_mfma_f32_16x16x32_bf16 v[168:171], v[40:43], v[96:99], v[168:171]
    ds_read_b64_tr_b16 v[38:39], v5 offset:63488
    v_fma_f32 v77, v77, s26, v11
    v_mfma_f32_16x16x32_bf16 v[232:235], v[40:43], v[104:107], v[232:235]
    v_exp_f32 v74, v74
    v_mfma_f32_16x16x32_bf16 a[168:171], v[40:43], v[112:115], a[168:171]
    v_exp_f32 v75, v75
    v_mfma_f32_16x16x32_bf16 a[232:235], v[40:43], v[120:123], a[232:235]
    s_waitcnt lgkmcnt(4)
    ds_read_b64_tr_b16 v[40:41], v6 offset:61440
    v_add_f32 v19, v19, v74
    v_mfma_f32_16x16x32_bf16 a[236:239], v[44:47], v[120:123], a[236:239]
    ds_read_b64_tr_b16 v[42:43], v6 offset:63488
    v_add_f32 v19, v19, v75
    v_mfma_f32_16x16x32_bf16 a[172:175], v[44:47], v[112:115], a[172:175]
    v_cvt_pk_bf16_f32 v73, v74, v75
    v_mfma_f32_16x16x32_bf16 v[236:239], v[44:47], v[104:107], v[236:239]
    v_exp_f32 v76, v76
    v_mfma_f32_16x16x32_bf16 v[172:175], v[44:47], v[96:99], v[172:175]
    s_waitcnt lgkmcnt(4)
    ds_read_b64_tr_b16 v[44:45], v7 offset:61440
    v_fma_f32 v78, v78, s26, v11
    v_mfma_f32_16x16x32_bf16 v[176:179], v[32:35], v[96:99], v[176:179]
    ds_read_b64_tr_b16 v[46:47], v7 offset:63488
    v_fma_f32 v79, v79, s26, v11
    v_mfma_f32_16x16x32_bf16 v[240:243], v[32:35], v[104:107], v[240:243]
    v_exp_f32 v77, v77
    v_mfma_f32_16x16x32_bf16 a[176:179], v[32:35], v[112:115], a[176:179]
    v_add_f32 v19, v19, v76
    v_add_f32 v19, v19, v77
    v_mfma_f32_16x16x32_bf16 a[240:243], v[32:35], v[120:123], a[240:243]
    s_waitcnt lgkmcnt(4)
    ds_read_b128 v[32:35], v2 offset:16384
    v_cvt_pk_bf16_f32 v74, v76, v77
    v_mfma_f32_16x16x32_bf16 a[244:247], v[36:39], v[120:123], a[244:247]
    v_exp_f32 v78, v78
    v_mfma_f32_16x16x32_bf16 a[180:183], v[36:39], v[112:115], a[180:183]
    v_exp_f32 v79, v79
    v_mfma_f32_16x16x32_bf16 v[244:247], v[36:39], v[104:107], v[244:247]
    v_fma_f32 v80, v80, s26, v12
    v_mfma_f32_16x16x32_bf16 v[180:183], v[36:39], v[96:99], v[180:183]
    s_waitcnt lgkmcnt(3)
    ds_read_b128 v[36:39], v2 offset:18432
    v_fma_f32 v81, v81, s26, v12
    v_mfma_f32_16x16x32_bf16 v[184:187], v[40:43], v[96:99], v[184:187]
    v_add_f32 v19, v19, v78
    v_mfma_f32_16x16x32_bf16 v[248:251], v[40:43], v[104:107], v[248:251]
    v_mfma_f32_16x16x32_bf16 a[184:187], v[40:43], v[112:115], a[184:187]
    v_add_f32 v19, v19, v79
    v_mfma_f32_16x16x32_bf16 a[248:251], v[40:43], v[120:123], a[248:251]
    s_waitcnt lgkmcnt(2)
    ds_read_b128 v[40:43], v3 offset:16384
    v_cvt_pk_bf16_f32 v75, v78, v79
    v_mfma_f32_16x16x32_bf16 a[252:255], v[44:47], v[120:123], a[252:255]
    v_exp_f32 v80, v80
    v_mfma_f32_16x16x32_bf16 a[188:191], v[44:47], v[112:115], a[188:191]
    v_exp_f32 v81, v81
    v_mfma_f32_16x16x32_bf16 v[252:255], v[44:47], v[104:107], v[252:255]
    v_fma_f32 v82, v82, s26, v12
    v_mfma_f32_16x16x32_bf16 v[188:191], v[44:47], v[96:99], v[188:191]
    s_waitcnt lgkmcnt(2)
    ds_read_b128 v[44:47], v3 offset:18432
    v_mfma_f32_16x16x32_bf16 v[120:123], v[32:35], a[96:99], 0
    s_waitcnt vmcnt(7)
    v_fma_f32 v83, v83, s26, v12
    v_add_f32 v20, v80, v81
    v_mfma_f32_16x16x32_bf16 v[112:115], v[32:35], a[64:67], 0
    s_barrier
    v_mfma_f32_16x16x32_bf16 v[104:107], v[32:35], a[32:35], 0
    v_cvt_pk_bf16_f32 v80, v80, v81
    v_mfma_f32_16x16x32_bf16 v[96:99], v[32:35], a[0:3], 0
    s_waitcnt lgkmcnt(2)
    ds_read_b128 v[32:35], v2 offset:20480
    v_mfma_f32_16x16x32_bf16 v[100:103], v[36:39], a[0:3], 0
    s_add_u32 m0, s21, 49152
    v_exp_f32 v82, v82
    v_mfma_f32_16x16x32_bf16 v[108:111], v[36:39], a[32:35], 0
    buffer_load_dwordx4 v9, s[12:15], s23 offen offset:0 lds
    v_mfma_f32_16x16x32_bf16 v[116:119], v[36:39], a[64:67], 0
    v_exp_f32 v83, v83
    v_mfma_f32_16x16x32_bf16 v[124:127], v[36:39], a[96:99], 0
    s_waitcnt lgkmcnt(2)
    ds_read_b128 v[36:39], v2 offset:22528
    v_fma_f32 v84, v84, s26, v12
    v_mfma_f32_16x16x32_bf16 v[120:123], v[40:43], a[100:103], v[120:123]
    s_add_u32 m0, s21, 53120
    v_fma_f32 v85, v85, s26, v12
    v_add_f32 v20, v20, v82
    v_mfma_f32_16x16x32_bf16 v[112:115], v[40:43], a[68:71], v[112:115]
    buffer_load_dwordx4 v9, s[12:15], s23 offen offset:128 lds
    v_mfma_f32_16x16x32_bf16 v[104:107], v[40:43], a[36:39], v[104:107]
    v_add_f32 v20, v20, v83
    v_cvt_pk_bf16_f32 v81, v82, v83
    v_mfma_f32_16x16x32_bf16 v[96:99], v[40:43], a[4:7], v[96:99]
    s_waitcnt lgkmcnt(2)
    ds_read_b128 v[40:43], v3 offset:20480
    v_mfma_f32_16x16x32_bf16 v[100:103], v[44:47], a[4:7], v[100:103]
    s_add_u32 m0, s21, 57088
    v_exp_f32 v84, v84
    v_mfma_f32_16x16x32_bf16 v[108:111], v[44:47], a[36:39], v[108:111]
    buffer_load_dwordx4 v9, s[12:15], s23 offen offset:256 lds
    v_mfma_f32_16x16x32_bf16 v[116:119], v[44:47], a[68:71], v[116:119]
    v_exp_f32 v85, v85
    v_mfma_f32_16x16x32_bf16 v[124:127], v[44:47], a[100:103], v[124:127]
    s_waitcnt lgkmcnt(2)
    ds_read_b128 v[44:47], v3 offset:22528
    v_fma_f32 v86, v86, s26, v12
    v_mfma_f32_16x16x32_bf16 v[120:123], v[32:35], a[104:107], v[120:123]
    s_add_u32 m0, s21, 61056
    v_fma_f32 v87, v87, s26, v12
    v_add_f32 v20, v20, v84
    v_mfma_f32_16x16x32_bf16 v[112:115], v[32:35], a[72:75], v[112:115]
    buffer_load_dwordx4 v9, s[12:15], s23 offen offset:384 lds
    v_mfma_f32_16x16x32_bf16 v[104:107], v[32:35], a[40:43], v[104:107]
    s_add_u32 s23, s23, 16384
    v_add_f32 v20, v20, v85
    v_cvt_pk_bf16_f32 v82, v84, v85
    v_mfma_f32_16x16x32_bf16 v[96:99], v[32:35], a[8:11], v[96:99]
    s_waitcnt lgkmcnt(2)
    ds_read_b128 v[32:35], v2 offset:24576
    v_fma_f32 v88, v88, s26, v13
    v_mfma_f32_16x16x32_bf16 v[100:103], v[36:39], a[8:11], v[100:103]
    s_cmp_eq_u32 s23, s30
    s_cselect_b32 s23, s31, s23
    v_fma_f32 v89, v89, s26, v13
    v_mfma_f32_16x16x32_bf16 v[108:111], v[36:39], a[40:43], v[108:111]
    v_exp_f32 v86, v86
    v_mfma_f32_16x16x32_bf16 v[116:119], v[36:39], a[72:75], v[116:119]
    v_exp_f32 v87, v87
    v_mfma_f32_16x16x32_bf16 v[124:127], v[36:39], a[104:107], v[124:127]
    s_waitcnt lgkmcnt(2)
    ds_read_b128 v[36:39], v2 offset:26624
    v_add_f32 v20, v20, v86
    v_mfma_f32_16x16x32_bf16 v[120:123], v[40:43], a[108:111], v[120:123]
    v_add_f32 v20, v20, v87
    v_cvt_pk_bf16_f32 v83, v86, v87
    v_mfma_f32_16x16x32_bf16 v[112:115], v[40:43], a[76:79], v[112:115]
    v_mfma_f32_16x16x32_bf16 v[104:107], v[40:43], a[44:47], v[104:107]
    v_exp_f32 v88, v88
    v_mfma_f32_16x16x32_bf16 v[96:99], v[40:43], a[12:15], v[96:99]
    s_waitcnt lgkmcnt(2)
    ds_read_b128 v[40:43], v3 offset:24576
    v_fma_f32 v90, v90, s26, v13
    v_mfma_f32_16x16x32_bf16 v[100:103], v[44:47], a[12:15], v[100:103]
    v_exp_f32 v89, v89
    v_mfma_f32_16x16x32_bf16 v[108:111], v[44:47], a[44:47], v[108:111]
    v_mfma_f32_16x16x32_bf16 v[116:119], v[44:47], a[76:79], v[116:119]
    v_fma_f32 v91, v91, s26, v13
    v_add_f32 v21, v88, v89
    v_mfma_f32_16x16x32_bf16 v[124:127], v[44:47], a[108:111], v[124:127]
    s_waitcnt lgkmcnt(2)
    ds_read_b128 v[44:47], v3 offset:26624
    v_cvt_pk_bf16_f32 v88, v88, v89
    v_mfma_f32_16x16x32_bf16 v[120:123], v[32:35], a[112:115], v[120:123]
    v_exp_f32 v90, v90
    v_mfma_f32_16x16x32_bf16 v[112:115], v[32:35], a[80:83], v[112:115]
    v_mfma_f32_16x16x32_bf16 v[104:107], v[32:35], a[48:51], v[104:107]
    v_fma_f32 v92, v92, s26, v13
    v_mfma_f32_16x16x32_bf16 v[96:99], v[32:35], a[16:19], v[96:99]
    s_waitcnt lgkmcnt(2)
    ds_read_b128 v[32:35], v2 offset:28672
    v_fma_f32 v93, v93, s26, v13
    v_mfma_f32_16x16x32_bf16 v[100:103], v[36:39], a[16:19], v[100:103]
    v_exp_f32 v91, v91
    v_mfma_f32_16x16x32_bf16 v[108:111], v[36:39], a[48:51], v[108:111]
    v_add_f32 v21, v21, v90
    v_add_f32 v21, v21, v91
    v_mfma_f32_16x16x32_bf16 v[116:119], v[36:39], a[80:83], v[116:119]
    v_cvt_pk_bf16_f32 v89, v90, v91
    v_mfma_f32_16x16x32_bf16 v[124:127], v[36:39], a[112:115], v[124:127]
    s_waitcnt lgkmcnt(2)
    ds_read_b128 v[36:39], v2 offset:30720
    v_mfma_f32_16x16x32_bf16 v[120:123], v[40:43], a[116:119], v[120:123]
    v_exp_f32 v92, v92
    v_mfma_f32_16x16x32_bf16 v[112:115], v[40:43], a[84:87], v[112:115]
    v_exp_f32 v93, v93
    v_mfma_f32_16x16x32_bf16 v[104:107], v[40:43], a[52:55], v[104:107]
    v_fma_f32 v94, v94, s26, v13
    v_fma_f32 v95, v95, s26, v13
    v_mfma_f32_16x16x32_bf16 v[96:99], v[40:43], a[20:23], v[96:99]
    s_waitcnt lgkmcnt(2)
    ds_read_b128 v[40:43], v3 offset:28672
    v_add_f32 v21, v21, v92
    v_mfma_f32_16x16x32_bf16 v[100:103], v[44:47], a[20:23], v[100:103]
    v_add_f32 v21, v21, v93
    v_add_f32 v22, v18, v19
    v_mfma_f32_16x16x32_bf16 v[108:111], v[44:47], a[52:55], v[108:111]
    v_cvt_pk_bf16_f32 v90, v92, v93
    v_mfma_f32_16x16x32_bf16 v[116:119], v[44:47], a[84:87], v[116:119]
    v_exp_f32 v94, v94
    v_mfma_f32_16x16x32_bf16 v[124:127], v[44:47], a[116:119], v[124:127]
    s_waitcnt lgkmcnt(2)
    ds_read_b128 v[44:47], v3 offset:30720
    v_mfma_f32_16x16x32_bf16 v[120:123], v[32:35], a[120:123], v[120:123]
    v_exp_f32 v95, v95
    v_mfma_f32_16x16x32_bf16 v[112:115], v[32:35], a[88:91], v[112:115]
    v_add_f32 v21, v21, v94
    v_add_f32 v21, v21, v95
    v_mfma_f32_16x16x32_bf16 v[104:107], v[32:35], a[56:59], v[104:107]
    v_cvt_pk_bf16_f32 v91, v94, v95
    v_add_f32 v23, v20, v21
    v_mfma_f32_16x16x32_bf16 v[96:99], v[32:35], a[24:27], v[96:99]
    s_waitcnt lgkmcnt(2)
    ds_read_b64_tr_b16 v[32:33], v4 offset:32768
    v_add_f32 v22, v22, v23
    v_mfma_f32_16x16x32_bf16 v[100:103], v[36:39], a[24:27], v[100:103]
    ds_read_b64_tr_b16 v[34:35], v4 offset:34816
    v_cmp_nge_f32 vcc, s27, v22
    v_mfma_f32_16x16x32_bf16 v[108:111], v[36:39], a[56:59], v[108:111]
    v_mfma_f32_16x16x32_bf16 v[116:119], v[36:39], a[88:91], v[116:119]
    s_cbranch_vccnz L_stub_it0b
L_ret_it0b:
    v_mfma_f32_16x16x32_bf16 v[124:127], v[36:39], a[120:123], v[124:127]
    s_waitcnt lgkmcnt(3)
    ds_read_b64_tr_b16 v[36:37], v5 offset:32768
    v_add_f32 v14, v14, v18
    v_mfma_f32_16x16x32_bf16 v[120:123], v[40:43], a[124:127], v[120:123]
    s_add_u32 s29, s29, 16384
    ds_read_b64_tr_b16 v[38:39], v5 offset:34816
    v_add_f32 v15, v15, v19
    v_mfma_f32_16x16x32_bf16 v[112:115], v[40:43], a[92:95], v[112:115]
    v_add_f32 v16, v16, v20
    v_add_f32 v17, v17, v21
    v_mfma_f32_16x16x32_bf16 v[104:107], v[40:43], a[60:63], v[104:107]
    v_mfma_f32_16x16x32_bf16 v[96:99], v[40:43], a[28:31], v[96:99]
    s_waitcnt lgkmcnt(4)
    ds_read_b64_tr_b16 v[40:41], v6 offset:32768
    v_mfma_f32_16x16x32_bf16 v[100:103], v[44:47], a[28:31], v[100:103]
    ds_read_b64_tr_b16 v[42:43], v6 offset:34816
    v_mfma_f32_16x16x32_bf16 v[108:111], v[44:47], a[60:63], v[108:111]
    v_mfma_f32_16x16x32_bf16 v[116:119], v[44:47], a[92:95], v[116:119]
    v_mfma_f32_16x16x32_bf16 v[124:127], v[44:47], a[124:127], v[124:127]
    s_waitcnt lgkmcnt(4)
    ds_read_b64_tr_b16 v[44:45], v7 offset:32768
    v_mfma_f32_16x16x32_bf16 v[128:131], v[32:35], v[64:67], v[128:131]
    ds_read_b64_tr_b16 v[46:47], v7 offset:34816
    v_fma_f32 v96, v96, s26, v10
    v_mfma_f32_16x16x32_bf16 v[192:195], v[32:35], v[72:75], v[192:195]
    s_waitcnt vmcnt(4)
    v_fma_f32 v97, v97, s26, v10
    v_mfma_f32_16x16x32_bf16 a[128:131], v[32:35], v[80:83], a[128:131]
    s_barrier
    v_mfma_f32_16x16x32_bf16 a[192:195], v[32:35], v[88:91], a[192:195]
    s_waitcnt lgkmcnt(4)
    ds_read_b64_tr_b16 v[32:33], v4 offset:36864
    v_mfma_f32_16x16x32_bf16 a[196:199], v[36:39], v[88:91], a[196:199]
    ds_read_b64_tr_b16 v[34:35], v4 offset:38912
    v_fma_f32 v98, v98, s26, v10
    v_mfma_f32_16x16x32_bf16 a[132:135], v[36:39], v[80:83], a[132:135]
    s_add_u32 m0, s21, 16384
    v_exp_f32 v96, v96
    v_mfma_f32_16x16x32_bf16 v[196:199], v[36:39], v[72:75], v[196:199]
    buffer_load_dwordx4 v8, s[8:11], s22 offen offset:0 lds
    v_mfma_f32_16x16x32_bf16 v[132:135], v[36:39], v[64:67], v[132:135]
    s_waitcnt lgkmcnt(4)
    ds_read_b64_tr_b16 v[36:37], v5 offset:36864
    v_fma_f32 v99, v99, s26, v10
    v_mfma_f32_16x16x32_bf16 v[136:139], v[40:43], v[64:67], v[136:139]
    ds_read_b64_tr_b16 v[38:39], v5 offset:38912
    v_mfma_f32_16x16x32_bf16 v[200:203], v[40:43], v[72:75], v[200:203]
    s_add_u32 m0, s21, 20352
    v_exp_f32 v97, v97
    v_mfma_f32_16x16x32_bf16 a[136:139], v[40:43], v[80:83], a[136:139]
    buffer_load_dwordx4 v8, s[8:11], s22 offen offset:128 lds
    v_mfma_f32_16x16x32_bf16 a[200:203], v[40:43], v[88:91], a[200:203]
    s_waitcnt lgkmcnt(4)
    ds_read_b64_tr_b16 v[40:41], v6 offset:36864
    v_add_f32 v18, v96, v97
    v_mfma_f32_16x16x32_bf16 a[204:207], v[44:47], v[88:91], a[204:207]
    ds_read_b64_tr_b16 v[42:43], v6 offset:38912
    v_cvt_pk_bf16_f32 v96, v96, v97
    v_mfma_f32_16x16x32_bf16 a[140:143], v[44:47], v[80:83], a[140:143]
    s_add_u32 m0, s21, 24320
    v_exp_f32 v98, v98
    v_mfma_f32_16x16x32_bf16 v[204:207], v[44:47], v[72:75], v[204:207]
    buffer_load_dwordx4 v8, s[8:11], s22 offen offset:256 lds
    v_mfma_f32_16x16x32_bf16 v[140:143], v[44:47], v[64:67], v[140:143]
    s_waitcnt lgkmcnt(4)
    ds_read_b64_tr_b16 v[44:45], v7 offset:36864
    v_fma_f32 v100, v100, s26, v10
    v_mfma_f32_16x16x32_bf16 v[144:147], v[32:35], v[64:67], v[144:147]
    ds_read_b64_tr_b16 v[46:47], v7 offset:38912
    v_fma_f32 v101, v101, s26, v10
    v_mfma_f32_16x16x32_bf16 v[208:211], v[32:35], v[72:75], v[208:211]
    s_add_u32 m0, s21, 28288
    v_exp_f32 v99, v99
    v_mfma_f32_16x16x32_bf16 a[144:147], v[32:35], v[80:83], a[144:147]
    buffer_load_dwordx4 v8, s[8:11], s22 offen offset:384 lds
    v_mfma_f32_16x16x32_bf16 a[208:211], v[32:35], v[88:91], a[208:211]
    s_waitcnt lgkmcnt(4)
    ds_read_b64_tr_b16 v[32:33], v4 offset:40960
    v_add_f32 v18, v18, v98
    v_mfma_f32_16x16x32_bf16 a[212:215], v[36:39], v[88:91], a[212:215]
    s_add_u32 s22, s22, 16384
    ds_read_b64_tr_b16 v[34:35], v4 offset:43008
    v_add_f32 v18, v18, v99
    v_mfma_f32_16x16x32_bf16 a[148:151], v[36:39], v[80:83], a[148:151]
    s_cmp_eq_u32 s22, s30
    s_cselect_b32 s22, s31, s22
    v_cvt_pk_bf16_f32 v97, v98, v99
    v_mfma_f32_16x16x32_bf16 v[212:215], v[36:39], v[72:75], v[212:215]
    v_exp_f32 v100, v100
    v_mfma_f32_16x16x32_bf16 v[148:151], v[36:39], v[64:67], v[148:151]
    s_waitcnt lgkmcnt(4)
    ds_read_b64_tr_b16 v[36:37], v5 offset:40960
    v_fma_f32 v102, v102, s26, v10
    v_mfma_f32_16x16x32_bf16 v[152:155], v[40:43], v[64:67], v[152:155]
    ds_read_b64_tr_b16 v[38:39], v5 offset:43008
    v_fma_f32 v103, v103, s26, v10
    v_mfma_f32_16x16x32_bf16 v[216:219], v[40:43], v[72:75], v[216:219]
    v_exp_f32 v101, v101
    v_mfma_f32_16x16x32_bf16 a[152:155], v[40:43], v[80:83], a[152:155]
    v_add_f32 v18, v18, v100
    v_add_f32 v18, v18, v101
    v_mfma_f32_16x16x32_bf16 a[216:219], v[40:43], v[88:91], a[216:219]
    s_waitcnt lgkmcnt(4)
    ds_read_b64_tr_b16 v[40:41], v6 offset:40960
    v_cvt_pk_bf16_f32 v98, v100, v101
    v_mfma_f32_16x16x32_bf16 a[220:223], v[44:47], v[88:91], a[220:223]
    ds_read_b64_tr_b16 v[42:43], v6 offset:43008
    v_fma_f32 v104, v104, s26, v11
    v_mfma_f32_16x16x32_bf16 a[156:159], v[44:47], v[80:83], a[156:159]
    v_exp_f32 v102, v102
    v_mfma_f32_16x16x32_bf16 v[220:223], v[44:47], v[72:75], v[220:223]
    v_exp_f32 v103, v103
    v_mfma_f32_16x16x32_bf16 v[156:159], v[44:47], v[64:67], v[156:159]
    s_waitcnt lgkmcnt(4)
    ds_read_b64_tr_b16 v[44:45], v7 offset:40960
    v_fma_f32 v105, v105, s26, v11
    v_mfma_f32_16x16x32_bf16 v[160:163], v[32:35], v[64:67], v[160:163]
    ds_read_b64_tr_b16 v[46:47], v7 offset:43008
    v_add_f32 v18, v18, v102
    v_mfma_f32_16x16x32_bf16 v[224:227], v[32:35], v[72:75], v[224:227]
    v_add_f32 v18, v18, v103
    v_cvt_pk_bf16_f32 v99, v102, v103
    v_mfma_f32_16x16x32_bf16 a[160:163], v[32:35], v[80:83], a[160:163]
    v_exp_f32 v104, v104
    v_mfma_f32_16x16x32_bf16 a[224:227], v[32:35], v[88:91], a[224:227]
    s_waitcnt lgkmcnt(4)
    ds_read_b64_tr_b16 v[32:33], v4 offset:45056
    v_fma_f32 v106, v106, s26, v11
    v_mfma_f32_16x16x32_bf16 a[228:231], v[36:39], v[88:91], a[228:231]
    ds_read_b64_tr_b16 v[34:35], v4 offset:47104
    v_fma_f32 v107, v107, s26, v11
    v_mfma_f32_16x16x32_bf16 a[164:167], v[36:39], v[80:83], a[164:167]
    v_exp_f32 v105, v105
    v_mfma_f32_16x16x32_bf16 v[228:231], v[36:39], v[72:75], v[228:231]
    v_add_f32 v19, v104, v105
    v_cvt_pk_bf16_f32 v104, v104, v105
    v_mfma_f32_16x16x32_bf16 v[164:167], v[36:39], v[64:67], v[164:167]
    s_waitcnt lgkmcnt(4)
    ds_read_b64_tr_b16 v[36:37], v5 offset:45056
    v_fma_f32 v108, v108, s26, v11
    v_mfma_f32_16x16x32_bf16 v[168:171], v[40:43], v[64:67], v[168:171]
    ds_read_b64_tr_b16 v[38:39], v5 offset:47104
    v_fma_f32 v109, v109, s26, v11
    v_mfma_f32_16x16x32_bf16 v[232:235], v[40:43], v[72:75], v[232:235]
    v_exp_f32 v106, v106
    v_mfma_f32_16x16x32_bf16 a[168:171], v[40:43], v[80:83], a[168:171]
    v_exp_f32 v107, v107
    v_mfma_f32_16x16x32_bf16 a[232:235], v[40:43], v[88:91], a[232:235]
    s_waitcnt lgkmcnt(4)
    ds_read_b64_tr_b16 v[40:41], v6 offset:45056
    v_add_f32 v19, v19, v106
    v_mfma_f32_16x16x32_bf16 a[236:239], v[44:47], v[88:91], a[236:239]
    ds_read_b64_tr_b16 v[42:43], v6 offset:47104
    v_add_f32 v19, v19, v107
    v_mfma_f32_16x16x32_bf16 a[172:175], v[44:47], v[80:83], a[172:175]
    v_cvt_pk_bf16_f32 v105, v106, v107
    v_mfma_f32_16x16x32_bf16 v[236:239], v[44:47], v[72:75], v[236:239]
    v_exp_f32 v108, v108
    v_mfma_f32_16x16x32_bf16 v[172:175], v[44:47], v[64:67], v[172:175]
    s_waitcnt lgkmcnt(4)
    ds_read_b64_tr_b16 v[44:45], v7 offset:45056
    v_fma_f32 v110, v110, s26, v11
    v_mfma_f32_16x16x32_bf16 v[176:179], v[32:35], v[64:67], v[176:179]
    ds_read_b64_tr_b16 v[46:47], v7 offset:47104
    v_fma_f32 v111, v111, s26, v11
    v_mfma_f32_16x16x32_bf16 v[240:243], v[32:35], v[72:75], v[240:243]
    v_exp_f32 v109, v109
    v_mfma_f32_16x16x32_bf16 a[176:179], v[32:35], v[80:83], a[176:179]
    v_add_f32 v19, v19, v108
    v_add_f32 v19, v19, v109
    v_mfma_f32_16x16x32_bf16 a[240:243], v[32:35], v[88:91], a[240:243]
    s_waitcnt lgkmcnt(4)
    ds_read_b128 v[32:35], v2 offset:0
    v_cvt_pk_bf16_f32 v106, v108, v109
    v_mfma_f32_16x16x32_bf16 a[244:247], v[36:39], v[88:91], a[244:247]
    v_exp_f32 v110, v110
    v_mfma_f32_16x16x32_bf16 a[180:183], v[36:39], v[80:83], a[180:183]
    v_exp_f32 v111, v111
    v_mfma_f32_16x16x32_bf16 v[244:247], v[36:39], v[72:75], v[244:247]
    v_fma_f32 v112, v112, s26, v12
    v_mfma_f32_16x16x32_bf16 v[180:183], v[36:39], v[64:67], v[180:183]
    s_waitcnt lgkmcnt(3)
    ds_read_b128 v[36:39], v2 offset:2048
    v_fma_f32 v113, v113, s26, v12
    v_mfma_f32_16x16x32_bf16 v[184:187], v[40:43], v[64:67], v[184:187]
    v_add_f32 v19, v19, v110
    v_mfma_f32_16x16x32_bf16 v[248:251], v[40:43], v[72:75], v[248:251]
    v_mfma_f32_16x16x32_bf16 a[184:187], v[40:43], v[80:83], a[184:187]
    v_add_f32 v19, v19, v111
    v_mfma_f32_16x16x32_bf16 a[248:251], v[40:43], v[88:91], a[248:251]
    s_waitcnt lgkmcnt(2)
    ds_read_b128 v[40:43], v3 offset:0
    v_cvt_pk_bf16_f32 v107, v110, v111
    v_mfma_f32_16x16x32_bf16 a[252:255], v[44:47], v[88:91], a[252:255]
    v_exp_f32 v112, v112
    v_mfma_f32_16x16x32_bf16 a[188:191], v[44:47], v[80:83], a[188:191]
    s_sub_u32 s24, s24, 1
    v_exp_f32 v113, v113
    v_mfma_f32_16x16x32_bf16 v[252:255], v[44:47], v[72:75], v[252:255]
    s_cmp_lg_u32 s24, 0
    v_fma_f32 v114, v114, s26, v12
    v_mfma_f32_16x16x32_bf16 v[188:191], v[44:47], v[64:67], v[188:191]
    s_waitcnt lgkmcnt(2)
    ds_read_b128 v[44:47], v3 offset:2048
    s_cbranch_scc1 L_loop0
L_tail0:
    s_waitcnt lgkmcnt(0)
    s_waitcnt vmcnt(4)
    v_fma_f32 v115, v115, s26, v12
    v_add_f32 v20, v112, v113
    s_barrier
    v_cvt_pk_bf16_f32 v112, v112, v113
    s_add_u32 m0, s21, 32768
    v_exp_f32 v114, v114
    buffer_load_dwordx4 v9, s[12:15], s23 offen offset:0 lds
    v_exp_f32 v115, v115
    v_fma_f32 v116, v116, s26, v12
    s_add_u32 m0, s21, 36736
    v_fma_f32 v117, v117, s26, v12
    v_add_f32 v20, v20, v114
    buffer_load_dwordx4 v9, s[12:15], s23 offen offset:128 lds
    v_add_f32 v20, v20, v115
    v_cvt_pk_bf16_f32 v113, v114, v115
    s_add_u32 m0, s21, 40704
    v_exp_f32 v116, v116
    buffer_load_dwordx4 v9, s[12:15], s23 offen offset:256 lds
    v_exp_f32 v117, v117
    v_fma_f32 v118, v118, s26, v12
    s_add_u32 m0, s21, 44672
    v_fma_f32 v119, v119, s26, v12
    v_add_f32 v20, v20, v116
    buffer_load_dwordx4 v9, s[12:15], s23 offen offset:384 lds
    s_add_u32 s23, s23, 16384
    v_add_f32 v20, v20, v117
    v_cvt_pk_bf16_f32 v114, v116, v117
    v_fma_f32 v120, v120, s26, v13
    s_cmp_eq_u32 s23, s30
    s_cselect_b32 s23, s31, s23
    v_fma_f32 v121, v121, s26, v13
    v_exp_f32 v118, v118
    v_exp_f32 v119, v119
    v_add_f32 v20, v20, v118
    v_add_f32 v20, v20, v119
    v_cvt_pk_bf16_f32 v115, v118, v119
    v_exp_f32 v120, v120
    v_fma_f32 v122, v122, s26, v13
    v_exp_f32 v121, v121
    v_fma_f32 v123, v123, s26, v13
    v_add_f32 v21, v120, v121
    v_cvt_pk_bf16_f32 v120, v120, v121
    v_exp_f32 v122, v122
    v_fma_f32 v124, v124, s26, v13
    v_fma_f32 v125, v125, s26, v13
    v_exp_f32 v123, v123
    v_add_f32 v21, v21, v122
    v_add_f32 v21, v21, v123
    v_cvt_pk_bf16_f32 v121, v122, v123
    v_exp_f32 v124, v124
    v_exp_f32 v125, v125
    v_fma_f32 v126, v126, s26, v13
    v_fma_f32 v127, v127, s26, v13
    v_add_f32 v21, v21, v124
    v_add_f32 v21, v21, v125
    v_add_f32 v22, v18, v19
    v_cvt_pk_bf16_f32 v122, v124, v125
    v_exp_f32 v126, v126
    v_exp_f32 v127, v127
    v_add_f32 v21, v21, v126
    v_add_f32 v21, v21, v127
    v_cvt_pk_bf16_f32 v123, v126, v127
    v_add_f32 v23, v20, v21
    v_add_f32 v22, v22, v23
    v_cmp_nge_f32 vcc, s27, v22
    s_nop 0
    s_cbranch_vccnz L_stub_it0i15
L_ret_it0i15:
    v_add_f32 v14, v14, v18
    s_add_u32 s29, s29, 16384
    v_add_f32 v15, v15, v19
    v_add_f32 v16, v16, v20
    v_add_f32 v17, v17, v21
    v_add_u32 v28, s39, v2
    v_add_u32 v29, s39, v3
    ds_read_b128 a[0:3], v28 offset:0
    v_mov_b32 v22, v14
    ds_read_b128 a[32:35], v28 offset:2048
    v_mov_b32 v23, v15
    ds_read_b128 a[64:67], v28 offset:4096
    v_mov_b32 v24, v16
    ds_read_b128 a[96:99], v28 offset:6144
    v_mov_b32 v25, v17
    ds_read_b128 a[4:7], v29 offset:0
    v_permlane32_swap_b32 v14, v22
    ds_read_b128 a[36:39], v29 offset:2048
    v_permlane32_swap_b32 v15, v23
    ds_read_b128 a[68:71], v29 offset:4096
    v_permlane32_swap_b32 v16, v24
    ds_read_b128 a[100:103], v29 offset:6144
    v_permlane32_swap_b32 v17, v25
    ds_read_b128 a[8:11], v28 offset:8192
    v_add_f32 v14, v14, v22
    ds_read_b128 a[40:43], v28 offset:10240
    v_add_f32 v15, v15, v23
    ds_read_b128 a[72:75], v28 offset:12288
    v_add_f32 v16, v16, v24
    ds_read_b128 a[104:107], v28 offset:14336
    v_add_f32 v17, v17, v25
    ds_read_b128 a[12:15], v29 offset:8192
    v_mov_b32 v22, v14
    ds_read_b128 a[44:47], v29 offset:10240
    v_mov_b32 v23, v15
    ds_read_b128 a[76:79], v29 offset:12288
    v_mov_b32 v24, v16
    ds_read_b128 a[108:111], v29 offset:14336
    v_mov_b32 v25, v17
    ds_read_b128 a[16:19], v28 offset:16384
    v_permlane16_swap_b32 v14, v22
    ds_read_b128 a[48:51], v28 offset:18432
    v_permlane16_swap_b32 v15, v23
    ds_read_b128 a[80:83], v28 offset:20480
    v_permlane16_swap_b32 v16, v24
    ds_read_b128 a[112:115], v28 offset:22528
    v_permlane16_swap_b32 v17, v25
    ds_read_b128 a[20:23], v29 offset:16384
    v_add_f32 v14, v14, v22
    ds_read_b128 a[52:55], v29 offset:18432
    v_add_f32 v15, v15, v23
    ds_read_b128 a[84:87], v29 offset:20480
    v_add_f32 v16, v16, v24
    ds_read_b128 a[116:119], v29 offset:22528
    v_add_f32 v17, v17, v25
    ds_read_b64_tr_b16 v[32:33], v4 offset:49152
    v_rcp_f32 v52, v14
    ds_read_b64_tr_b16 v[34:35], v4 offset:51200
    v_rcp_f32 v53, v15
    ds_read_b64_tr_b16 v[36:37], v5 offset:49152
    v_rcp_f32 v54, v16
    ds_read_b64_tr_b16 v[38:39], v5 offset:51200
    v_rcp_f32 v55, v17
    ds_read_b64_tr_b16 v[40:41], v6 offset:49152
    v_xor_b32 v25, 32, v61
    ds_read_b64_tr_b16 v[42:43], v6 offset:51200
    v_xor_b32 v26, 64, v61
    ds_read_b64_tr_b16 v[44:45], v7 offset:49152
    v_xor_b32 v27, 96, v61
    ds_read_b64_tr_b16 v[46:47], v7 offset:51200
    s_waitcnt lgkmcnt(0)
    v_xor_b32 v31, 64, v51
    s_add_u32 s82, s38, 0
    s_add_u32 s83, s38, 4096
    s_add_u32 s84, s38, 8192
    s_add_u32 s85, s38, 12288
    s_add_u32 s86, s38, 16384
    s_add_u32 s87, s38, 20480
    s_add_u32 s88, s38, 24576
    s_add_u32 s89, s38, 28672
    v_xor_b32 v28, 32, v49
    v_xor_b32 v29, 64, v49
    v_xor_b32 v30, 96, v49
    v_mfma_f32_16x16x32_bf16 v[128:131], v[32:35], v[96:99], v[128:131]
    ds_read_b64_tr_b16 v[46:47], v7 offset:51200
    v_mfma_f32_16x16x32_bf16 v[192:195], v[32:35], v[104:107], v[192:195]
    s_waitcnt vmcnt(4)
    v_mfma_f32_16x16x32_bf16 a[128:131], v[32:35], v[112:115], a[128:131]
    s_barrier
    v_mfma_f32_16x16x32_bf16 a[192:195], v[32:35], v[120:123], a[192:195]
    ds_read_b64_tr_b16 v[32:33], v4 offset:53248
    v_mfma_f32_16x16x32_bf16 a[196:199], v[36:39], v[120:123], a[196:199]
    s_add_u32 m0, s39, 16000
    ds_read_b64_tr_b16 v[34:35], v4 offset:55296
    v_mfma_f32_16x16x32_bf16 a[132:135], v[36:39], v[112:115], a[132:135]
    buffer_load_dwordx4 v51, s[4:7], s82 offen offset:384 nt lds
    v_mfma_f32_16x16x32_bf16 v[196:199], v[36:39], v[104:107], v[196:199]
    v_mul_f32 v128, v128, v52
    v_mul_f32 v129, v129, v52
    v_mfma_f32_16x16x32_bf16 v[132:135], v[36:39], v[96:99], v[132:135]
    ds_read_b64_tr_b16 v[36:37], v5 offset:53248
    v_mul_f32 v130, v130, v52
    v_mfma_f32_16x16x32_bf16 v[136:139], v[40:43], v[96:99], v[136:139]
    s_add_u32 m0, s39, 17024
    ds_read_b64_tr_b16 v[38:39], v5 offset:55296
    v_mul_f32 v131, v131, v52
    v_mfma_f32_16x16x32_bf16 v[200:203], v[40:43], v[104:107], v[200:203]
    buffer_load_dwordx4 v31, s[4:7], s83 offen offset:384 nt lds
    v_mfma_f32_16x16x32_bf16 a[136:139], v[40:43], v[112:115], a[136:139]
    v_cvt_pk_bf16_f32 v64, v128, v129
    v_cvt_pk_bf16_f32 v65, v130, v131
    v_mfma_f32_16x16x32_bf16 a[200:203], v[40:43], v[120:123], a[200:203]
    s_waitcnt lgkmcnt(4)
    ds_read_b64_tr_b16 v[40:41], v6 offset:53248
    v_mfma_f32_16x16x32_bf16 a[204:207], v[44:47], v[120:123], a[204:207]
    s_add_u32 m0, s39, 18048
    ds_read_b64_tr_b16 v[42:43], v6 offset:55296
    v_mul_f32 v132, v132, v52
    v_mfma_f32_16x16x32_bf16 a[140:143], v[44:47], v[112:115], a[140:143]
    buffer_load_dwordx4 v51, s[4:7], s84 offen offset:384 nt lds
    v_mfma_f32_16x16x32_bf16 v[204:207], v[44:47], v[104:107], v[204:207]
    ds_write_b64 v61, v[64:65] offset:0
    v_mul_f32 v133, v133, v52
    v_mfma_f32_16x16x32_bf16 v[140:143], v[44:47], v[96:99], v[140:143]
    s_waitcnt lgkmcnt(5)
    ds_read_b64_tr_b16 v[44:45], v7 offset:53248
    v_mul_f32 v134, v134, v52
    v_mfma_f32_16x16x32_bf16 v[144:147], v[32:35], v[96:99], v[144:147]
    s_add_u32 m0, s39, 19072
    ds_read_b64_tr_b16 v[46:47], v7 offset:55296
    v_mul_f32 v135, v135, v52
    v_mfma_f32_16x16x32_bf16 v[208:211], v[32:35], v[104:107], v[208:211]
    buffer_load_dwordx4 v31, s[4:7], s85 offen offset:384 nt lds
    v_mfma_f32_16x16x32_bf16 a[144:147], v[32:35], v[112:115], a[144:147]
    v_cvt_pk_bf16_f32 v66, v132, v133
    v_cvt_pk_bf16_f32 v67, v134, v135
    v_mfma_f32_16x16x32_bf16 a[208:211], v[32:35], v[120:123], a[208:211]
    s_waitcnt lgkmcnt(5)
    ds_read_b64_tr_b16 v[32:33], v4 offset:57344
    v_mul_f32 v136, v136, v52
    v_mfma_f32_16x16x32_bf16 a[212:215], v[36:39], v[120:123], a[212:215]
    s_add_u32 m0, s39, 20096
    ds_read_b64_tr_b16 v[34:35], v4 offset:59392
    v_mul_f32 v137, v137, v52
    v_mfma_f32_16x16x32_bf16 a[148:151], v[36:39], v[112:115], a[148:151]
    buffer_load_dwordx4 v51, s[4:7], s86 offen offset:384 nt lds
    v_mfma_f32_16x16x32_bf16 v[212:215], v[36:39], v[104:107], v[212:215]
    ds_write_b64 v25, v[66:67] offset:0
    v_mul_f32 v138, v138, v52
    v_mfma_f32_16x16x32_bf16 v[148:151], v[36:39], v[96:99], v[148:151]
    s_waitcnt lgkmcnt(6)
    ds_read_b64_tr_b16 v[36:37], v5 offset:57344
    v_mul_f32 v139, v139, v52
    v_mfma_f32_16x16x32_bf16 v[152:155], v[40:43], v[96:99], v[152:155]
    s_add_u32 m0, s39, 21120
    ds_read_b64_tr_b16 v[38:39], v5 offset:59392
    v_cvt_pk_bf16_f32 v68, v136, v137
    v_mfma_f32_16x16x32_bf16 v[216:219], v[40:43], v[104:107], v[216:219]
    buffer_load_dwordx4 v31, s[4:7], s87 offen offset:384 nt lds
    v_mfma_f32_16x16x32_bf16 a[152:155], v[40:43], v[112:115], a[152:155]
    v_cvt_pk_bf16_f32 v69, v138, v139
    v_mul_f32 v140, v140, v52
    v_mfma_f32_16x16x32_bf16 a[216:219], v[40:43], v[120:123], a[216:219]
    s_waitcnt lgkmcnt(5)
    ds_read_b64_tr_b16 v[40:41], v6 offset:57344
    v_mul_f32 v141, v141, v52
    v_mfma_f32_16x16x32_bf16 a[220:223], v[44:47], v[120:123], a[220:223]
    s_add_u32 m0, s39, 22144
    ds_read_b64_tr_b16 v[42:43], v6 offset:59392
    v_mul_f32 v142, v142, v52
    v_mfma_f32_16x16x32_bf16 a[156:159], v[44:47], v[112:115], a[156:159]
    buffer_load_dwordx4 v51, s[4:7], s88 offen offset:384 nt lds
    v_mfma_f32_16x16x32_bf16 v[220:223], v[44:47], v[104:107], v[220:223]
    ds_write_b64 v26, v[68:69] offset:0
    v_mul_f32 v143, v143, v52
    v_mfma_f32_16x16x32_bf16 v[156:159], v[44:47], v[96:99], v[156:159]
    s_waitcnt lgkmcnt(6)
    ds_read_b64_tr_b16 v[44:45], v7 offset:57344
    v_cvt_pk_bf16_f32 v70, v140, v141
    v_mfma_f32_16x16x32_bf16 v[160:163], v[32:35], v[96:99], v[160:163]
    s_add_u32 m0, s39, 23168
    ds_read_b64_tr_b16 v[46:47], v7 offset:59392
    v_cvt_pk_bf16_f32 v71, v142, v143
    v_mfma_f32_16x16x32_bf16 v[224:227], v[32:35], v[104:107], v[224:227]
    buffer_load_dwordx4 v31, s[4:7], s89 offen offset:384 nt lds
    v_mfma_f32_16x16x32_bf16 a[160:163], v[32:35], v[112:115], a[160:163]
    ds_write_b64 v27, v[70:71] offset:0
    v_mul_f32 v144, v144, v52
    v_mfma_f32_16x16x32_bf16 a[224:227], v[32:35], v[120:123], a[224:227]
    s_waitcnt lgkmcnt(6)
    ds_read_b64_tr_b16 v[32:33], v4 offset:61440
    v_mul_f32 v145, v145, v52
    v_mfma_f32_16x16x32_bf16 a[228:231], v[36:39], v[120:123], a[228:231]
    ds_read_b64_tr_b16 v[34:35], v4 offset:63488
    v_mul_f32 v146, v146, v52
    v_mfma_f32_16x16x32_bf16 a[164:167], v[36:39], v[112:115], a[164:167]
    v_mul_f32 v147, v147, v52
    v_cvt_pk_bf16_f32 v64, v144, v145
    v_mfma_f32_16x16x32_bf16 v[228:231], v[36:39], v[104:107], v[228:231]
    v_cvt_pk_bf16_f32 v65, v146, v147
    v_mul_f32 v148, v148, v52
    v_mfma_f32_16x16x32_bf16 v[164:167], v[36:39], v[96:99], v[164:167]
    s_waitcnt lgkmcnt(6)
    ds_read_b64_tr_b16 v[36:37], v5 offset:61440
    v_mul_f32 v149, v149, v52
    v_mfma_f32_16x16x32_bf16 v[168:171], v[40:43], v[96:99], v[168:171]
    ds_read_b64_tr_b16 v[38:39], v5 offset:63488
    v_mul_f32 v150, v150, v52
    v_mfma_f32_16x16x32_bf16 v[232:235], v[40:43], v[104:107], v[232:235]
    ds_write_b64 v61, v[64:65] offset:128
    v_mul_f32 v151, v151, v52
    v_mfma_f32_16x16x32_bf16 a[168:171], v[40:43], v[112:115], a[168:171]
    v_cvt_pk_bf16_f32 v66, v148, v149
    v_cvt_pk_bf16_f32 v67, v150, v151
    v_mfma_f32_16x16x32_bf16 a[232:235], v[40:43], v[120:123], a[232:235]
    s_waitcnt lgkmcnt(6)
    ds_read_b64_tr_b16 v[40:41], v6 offset:61440
    v_mul_f32 v152, v152, v52
    v_mfma_f32_16x16x32_bf16 a[236:239], v[44:47], v[120:123], a[236:239]
    ds_read_b64_tr_b16 v[42:43], v6 offset:63488
    v_mul_f32 v153, v153, v52
    v_mfma_f32_16x16x32_bf16 a[172:175], v[44:47], v[112:115], a[172:175]
    ds_write_b64 v25, v[66:67] offset:128
    v_mul_f32 v154, v154, v52
    v_mfma_f32_16x16x32_bf16 v[236:239], v[44:47], v[104:107], v[236:239]
    v_mul_f32 v155, v155, v52
    v_cvt_pk_bf16_f32 v68, v152, v153
    v_mfma_f32_16x16x32_bf16 v[172:175], v[44:47], v[96:99], v[172:175]
    s_waitcnt lgkmcnt(6)
    ds_read_b64_tr_b16 v[44:45], v7 offset:61440
    v_cvt_pk_bf16_f32 v69, v154, v155
    v_mfma_f32_16x16x32_bf16 v[176:179], v[32:35], v[96:99], v[176:179]
    ds_read_b64_tr_b16 v[46:47], v7 offset:63488
    v_mul_f32 v156, v156, v52
    v_mfma_f32_16x16x32_bf16 v[240:243], v[32:35], v[104:107], v[240:243]
    ds_write_b64 v26, v[68:69] offset:128
    v_mul_f32 v157, v157, v52
    v_mfma_f32_16x16x32_bf16 a[176:179], v[32:35], v[112:115], a[176:179]
    v_mul_f32 v158, v158, v52
    v_mul_f32 v159, v159, v52
    v_mfma_f32_16x16x32_bf16 a[240:243], v[32:35], v[120:123], a[240:243]
    s_waitcnt lgkmcnt(7)
    v_cvt_pk_bf16_f32 v70, v156, v157
    v_cvt_pk_bf16_f32 v71, v158, v159
    v_mfma_f32_16x16x32_bf16 a[244:247], v[36:39], v[120:123], a[244:247]
    ds_write_b64 v27, v[70:71] offset:128
    v_mul_f32 v160, v160, v52
    v_mfma_f32_16x16x32_bf16 a[180:183], v[36:39], v[112:115], a[180:183]
    v_mul_f32 v161, v161, v52
    v_mul_f32 v162, v162, v52
    v_mfma_f32_16x16x32_bf16 v[244:247], v[36:39], v[104:107], v[244:247]
    v_mul_f32 v163, v163, v52
    v_cvt_pk_bf16_f32 v64, v160, v161
    v_mfma_f32_16x16x32_bf16 v[180:183], v[36:39], v[96:99], v[180:183]
    s_waitcnt lgkmcnt(5)
    v_cvt_pk_bf16_f32 v65, v162, v163
    v_mul_f32 v164, v164, v52
    v_mfma_f32_16x16x32_bf16 v[184:187], v[40:43], v[96:99], v[184:187]
    ds_write_b64 v61, v[64:65] offset:256
    v_mul_f32 v165, v165, v52
    v_mfma_f32_16x16x32_bf16 v[248:251], v[40:43], v[104:107], v[248:251]
    v_mul_f32 v166, v166, v52
    v_mul_f32 v167, v167, v52
    v_mfma_f32_16x16x32_bf16 a[184:187], v[40:43], v[112:115], a[184:187]
    v_cvt_pk_bf16_f32 v66, v164, v165
    v_cvt_pk_bf16_f32 v67, v166, v167
    v_mfma_f32_16x16x32_bf16 a[248:251], v[40:43], v[120:123], a[248:251]
    s_waitcnt lgkmcnt(3)
    ds_write_b64 v25, v[66:67] offset:256
    v_mul_f32 v168, v168, v52
    v_mfma_f32_16x16x32_bf16 a[252:255], v[44:47], v[120:123], a[252:255]
    v_mul_f32 v169, v169, v52
    v_mul_f32 v170, v170, v52
    v_mfma_f32_16x16x32_bf16 a[188:191], v[44:47], v[112:115], a[188:191]
    v_mul_f32 v171, v171, v52
    v_cvt_pk_bf16_f32 v68, v168, v169
    v_mfma_f32_16x16x32_bf16 v[252:255], v[44:47], v[104:107], v[252:255]
    v_cvt_pk_bf16_f32 v69, v170, v171
    v_mul_f32 v172, v172, v52
    v_mfma_f32_16x16x32_bf16 v[188:191], v[44:47], v[96:99], v[188:191]
    s_waitcnt lgkmcnt(12)
    ds_write_b64 v26, v[68:69] offset:256
    v_mul_f32 v173, v173, v52
    s_nop 7
    v_mul_f32 v174, v174, v52
    v_mul_f32 v175, v175, v52
    v_cvt_pk_bf16_f32 v70, v172, v173
    v_cvt_pk_bf16_f32 v71, v174, v175
    ds_write_b64 v27, v[70:71] offset:256
    v_mul_f32 v176, v176, v52
    v_mul_f32 v177, v177, v52
    v_mul_f32 v178, v178, v52
    v_mul_f32 v179, v179, v52
    v_cvt_pk_bf16_f32 v64, v176, v177
    v_cvt_pk_bf16_f32 v65, v178, v179
    ds_write_b64 v61, v[64:65] offset:384
    v_mul_f32 v180, v180, v52
    v_mul_f32 v181, v181, v52
    v_mul_f32 v182, v182, v52
    v_mul_f32 v183, v183, v52
    v_cvt_pk_bf16_f32 v66, v180, v181
    v_cvt_pk_bf16_f32 v67, v182, v183
    ds_write_b64 v25, v[66:67] offset:384
    v_mul_f32 v184, v184, v52
    v_mul_f32 v185, v185, v52
    v_mul_f32 v186, v186, v52
    v_mul_f32 v187, v187, v52
    v_cvt_pk_bf16_f32 v68, v184, v185
    v_cvt_pk_bf16_f32 v69, v186, v187
    ds_write_b64 v26, v[68:69] offset:384
    v_mul_f32 v188, v188, v52
    v_mul_f32 v189, v189, v52
    v_mul_f32 v190, v190, v52
    v_mul_f32 v191, v191, v52
    v_cvt_pk_bf16_f32 v70, v188, v189
    v_cvt_pk_bf16_f32 v71, v190, v191
    ds_write_b64 v27, v[70:71] offset:384
    ds_read_b128 v[96:99], v49 offset:0
    ds_read_b128 v[100:103], v28 offset:1024
    ds_read_b128 v[104:107], v29 offset:2048
    ds_read_b128 v[108:111], v30 offset:3072
    ds_read_b128 v[112:115], v49 offset:4096
    ds_read_b128 v[116:119], v28 offset:5120
    ds_read_b128 v[120:123], v29 offset:6144
    ds_read_b128 v[124:127], v30 offset:7168
    v_pk_mul_f32 v[192:193], v[192:193], v[52:53] op_sel:[0,1] op_sel_hi:[1,1]
    v_pk_mul_f32 v[194:195], v[194:195], v[52:53] op_sel:[0,1] op_sel_hi:[1,1]
    s_add_u32 s33, s28, 0
    s_add_u32 s34, s28, 4096
    s_waitcnt lgkmcnt(7)
    buffer_store_dwordx4 v[96:99], v50, s[16:19], s33 offen offset:0
    v_pk_mul_f32 v[196:197], v[196:197], v[52:53] op_sel:[0,1] op_sel_hi:[1,1]
    v_pk_mul_f32 v[198:199], v[198:199], v[52:53] op_sel:[0,1] op_sel_hi:[1,1]
    v_cvt_pk_bf16_f32 v64, v192, v193
    v_cvt_pk_bf16_f32 v65, v194, v195
    v_pk_mul_f32 v[200:201], v[200:201], v[52:53] op_sel:[0,1] op_sel_hi:[1,1]
    v_pk_mul_f32 v[202:203], v[202:203], v[52:53] op_sel:[0,1] op_sel_hi:[1,1]
    v_cvt_pk_bf16_f32 v66, v196, v197
    v_cvt_pk_bf16_f32 v67, v198, v199
    ds_write_b64 v61, v[64:65] offset:8192
    s_waitcnt lgkmcnt(7)
    buffer_store_dwordx4 v[100:103], v50, s[16:19], s33 offen offset:1024
    v_pk_mul_f32 v[204:205], v[204:205], v[52:53] op_sel:[0,1] op_sel_hi:[1,1]
    v_pk_mul_f32 v[206:207], v[206:207], v[52:53] op_sel:[0,1] op_sel_hi:[1,1]
    v_cvt_pk_bf16_f32 v68, v200, v201
    v_cvt_pk_bf16_f32 v69, v202, v203
    ds_write_b64 v25, v[66:67] offset:8192
    v_pk_mul_f32 v[208:209], v[208:209], v[52:53] op_sel:[0,1] op_sel_hi:[1,1]
    v_pk_mul_f32 v[210:211], v[210:211], v[52:53] op_sel:[0,1] op_sel_hi:[1,1]
    v_cvt_pk_bf16_f32 v70, v204, v205
    v_cvt_pk_bf16_f32 v71, v206, v207
    ds_write_b64 v26, v[68:69] offset:8192
    s_waitcnt lgkmcnt(8)
    buffer_store_dwordx4 v[104:107], v50, s[16:19], s33 offen offset:2048
    v_pk_mul_f32 v[212:213], v[212:213], v[52:53] op_sel:[0,1] op_sel_hi:[1,1]
    v_pk_mul_f32 v[214:215], v[214:215], v[52:53] op_sel:[0,1] op_sel_hi:[1,1]
    v_cvt_pk_bf16_f32 v64, v208, v209
    v_cvt_pk_bf16_f32 v65, v210, v211
    ds_write_b64 v27, v[70:71] offset:8192
    v_pk_mul_f32 v[216:217], v[216:217], v[52:53] op_sel:[0,1] op_sel_hi:[1,1]
    v_pk_mul_f32 v[218:219], v[218:219], v[52:53] op_sel:[0,1] op_sel_hi:[1,1]
    v_cvt_pk_bf16_f32 v66, v212, v213
    v_cvt_pk_bf16_f32 v67, v214, v215
    ds_write_b64 v61, v[64:65] offset:8320
    s_waitcnt lgkmcnt(9)
    buffer_store_dwordx4 v[108:111], v50, s[16:19], s33 offen offset:3072
    v_pk_mul_f32 v[220:221], v[220:221], v[52:53] op_sel:[0,1] op_sel_hi:[1,1]
    v_pk_mul_f32 v[222:223], v[222:223], v[52:53] op_sel:[0,1] op_sel_hi:[1,1]
    v_cvt_pk_bf16_f32 v68, v216, v217
    v_cvt_pk_bf16_f32 v69, v218, v219
    ds_write_b64 v25, v[66:67] offset:8320
    v_pk_mul_f32 v[224:225], v[224:225], v[52:53] op_sel:[0,1] op_sel_hi:[1,1]
    v_pk_mul_f32 v[226:227], v[226:227], v[52:53] op_sel:[0,1] op_sel_hi:[1,1]
    v_cvt_pk_bf16_f32 v70, v220, v221
    v_cvt_pk_bf16_f32 v71, v222, v223
    ds_write_b64 v26, v[68:69] offset:8320
    s_waitcnt lgkmcnt(10)
    buffer_store_dwordx4 v[112:115], v50, s[16:19], s34 offen offset:0
    v_pk_mul_f32 v[228:229], v[228:229], v[52:53] op_sel:[0,1] op_sel_hi:[1,1]
    v_pk_mul_f32 v[230:231], v[230:231], v[52:53] op_sel:[0,1] op_sel_hi:[1,1]
    v_cvt_pk_bf16_f32 v64, v224, v225
    v_cvt_pk_bf16_f32 v65, v226, v227
    ds_write_b64 v27, v[70:71] offset:8320
    v_pk_mul_f32 v[232:233], v[232:233], v[52:53] op_sel:[0,1] op_sel_hi:[1,1]
    v_pk_mul_f32 v[234:235], v[234:235], v[52:53] op_sel:[0,1] op_sel_hi:[1,1]
    v_cvt_pk_bf16_f32 v66, v228, v229
    v_cvt_pk_bf16_f32 v67, v230, v231
    ds_write_b64 v61, v[64:65] offset:8448
    s_waitcnt lgkmcnt(11)
    buffer_store_dwordx4 v[116:119], v50, s[16:19], s34 offen offset:1024
    v_pk_mul_f32 v[236:237], v[236:237], v[52:53] op_sel:[0,1] op_sel_hi:[1,1]
    v_pk_mul_f32 v[238:239], v[238:239], v[52:53] op_sel:[0,1] op_sel_hi:[1,1]
    v_cvt_pk_bf16_f32 v68, v232, v233
    v_cvt_pk_bf16_f32 v69, v234, v235
    ds_write_b64 v25, v[66:67] offset:8448
    v_pk_mul_f32 v[240:241], v[240:241], v[52:53] op_sel:[0,1] op_sel_hi:[1,1]
    v_pk_mul_f32 v[242:243], v[242:243], v[52:53] op_sel:[0,1] op_sel_hi:[1,1]
    v_cvt_pk_bf16_f32 v70, v236, v237
    v_cvt_pk_bf16_f32 v71, v238, v239
    ds_write_b64 v26, v[68:69] offset:8448
    s_waitcnt lgkmcnt(12)
    buffer_store_dwordx4 v[120:123], v50, s[16:19], s34 offen offset:2048
    v_pk_mul_f32 v[244:245], v[244:245], v[52:53] op_sel:[0,1] op_sel_hi:[1,1]
    v_pk_mul_f32 v[246:247], v[246:247], v[52:53] op_sel:[0,1] op_sel_hi:[1,1]
    v_cvt_pk_bf16_f32 v64, v240, v241
    v_cvt_pk_bf16_f32 v65, v242, v243
    ds_write_b64 v27, v[70:71] offset:8448
    v_pk_mul_f32 v[248:249], v[248:249], v[52:53] op_sel:[0,1] op_sel_hi:[1,1]
    v_pk_mul_f32 v[250:251], v[250:251], v[52:53] op_sel:[0,1] op_sel_hi:[1,1]
    v_cvt_pk_bf16_f32 v66, v244, v245
    v_cvt_pk_bf16_f32 v67, v246, v247
    ds_write_b64 v61, v[64:65] offset:8576
    s_waitcnt lgkmcnt(13)
    buffer_store_dwordx4 v[124:127], v50, s[16:19], s34 offen offset:3072
    v_accvgpr_read_b32 v72, a128
    v_accvgpr_read_b32 v73, a129
    v_accvgpr_read_b32 v74, a130
    v_accvgpr_read_b32 v75, a131
    v_pk_mul_f32 v[252:253], v[252:253], v[52:53] op_sel:[0,1] op_sel_hi:[1,1]
    v_pk_mul_f32 v[254:255], v[254:255], v[52:53] op_sel:[0,1] op_sel_hi:[1,1]
    v_cvt_pk_bf16_f32 v68, v248, v249
    v_cvt_pk_bf16_f32 v69, v250, v251
    ds_write_b64 v25, v[66:67] offset:8576
    v_accvgpr_read_b32 v76, a132
    v_accvgpr_read_b32 v77, a133
    v_accvgpr_read_b32 v78, a134
    v_accvgpr_read_b32 v79, a135
    v_pk_mul_f32 v[72:73], v[72:73], v[54:55] op_sel:[0,0] op_sel_hi:[1,0]
    v_pk_mul_f32 v[74:75], v[74:75], v[54:55] op_sel:[0,0] op_sel_hi:[1,0]
    v_cvt_pk_bf16_f32 v70, v252, v253
    v_cvt_pk_bf16_f32 v71, v254, v255
    ds_write_b64 v26, v[68:69] offset:8576
    v_accvgpr_read_b32 v80, a136
    v_accvgpr_read_b32 v81, a137
    v_accvgpr_read_b32 v82, a138
    v_accvgpr_read_b32 v83, a139
    v_pk_mul_f32 v[76:77], v[76:77], v[54:55] op_sel:[0,0] op_sel_hi:[1,0]
    v_pk_mul_f32 v[78:79], v[78:79], v[54:55] op_sel:[0,0] op_sel_hi:[1,0]
    v_cvt_pk_bf16_f32 v64, v72, v73
    v_cvt_pk_bf16_f32 v65, v74, v75
    ds_write_b64 v27, v[70:71] offset:8576
    ds_read_b128 v[96:99], v49 offset:8192
    ds_read_b128 v[100:103], v28 offset:9216
    ds_read_b128 v[104:107], v29 offset:10240
    ds_read_b128 v[108:111], v30 offset:11264
    ds_read_b128 v[112:115], v49 offset:12288
    ds_read_b128 v[116:119], v28 offset:13312
    ds_read_b128 v[120:123], v29 offset:14336
    ds_read_b128 v[124:127], v30 offset:15360
    v_accvgpr_read_b32 v84, a140
    v_accvgpr_read_b32 v85, a141
    v_accvgpr_read_b32 v86, a142
    v_accvgpr_read_b32 v87, a143
    v_pk_mul_f32 v[80:81], v[80:81], v[54:55] op_sel:[0,0] op_sel_hi:[1,0]
    v_pk_mul_f32 v[82:83], v[82:83], v[54:55] op_sel:[0,0] op_sel_hi:[1,0]
    v_cvt_pk_bf16_f32 v66, v76, v77
    v_cvt_pk_bf16_f32 v67, v78, v79
    ds_write_b64 v61, v[64:65] offset:0
    v_accvgpr_read_b32 v72, a144
    v_accvgpr_read_b32 v73, a145
    v_accvgpr_read_b32 v74, a146
    v_accvgpr_read_b32 v75, a147
    v_pk_mul_f32 v[84:85], v[84:85], v[54:55] op_sel:[0,0] op_sel_hi:[1,0]
    v_pk_mul_f32 v[86:87], v[86:87], v[54:55] op_sel:[0,0] op_sel_hi:[1,0]
    v_cvt_pk_bf16_f32 v68, v80, v81
    v_cvt_pk_bf16_f32 v69, v82, v83
    ds_write_b64 v25, v[66:67] offset:0
    s_add_u32 s33, s28, 8192
    s_add_u32 s34, s28, 12288
    s_waitcnt lgkmcnt(9)
    buffer_store_dwordx4 v[96:99], v50, s[16:19], s33 offen offset:0
    v_accvgpr_read_b32 v76, a148
    v_accvgpr_read_b32 v77, a149
    v_accvgpr_read_b32 v78, a150
    v_accvgpr_read_b32 v79, a151
    v_pk_mul_f32 v[72:73], v[72:73], v[54:55] op_sel:[0,0] op_sel_hi:[1,0]
    v_pk_mul_f32 v[74:75], v[74:75], v[54:55] op_sel:[0,0] op_sel_hi:[1,0]
    v_cvt_pk_bf16_f32 v70, v84, v85
    v_cvt_pk_bf16_f32 v71, v86, v87
    ds_write_b64 v26, v[68:69] offset:0
    v_accvgpr_read_b32 v80, a152
    v_accvgpr_read_b32 v81, a153
    v_accvgpr_read_b32 v82, a154
    v_accvgpr_read_b32 v83, a155
    v_pk_mul_f32 v[76:77], v[76:77], v[54:55] op_sel:[0,0] op_sel_hi:[1,0]
    v_pk_mul_f32 v[78:79], v[78:79], v[54:55] op_sel:[0,0] op_sel_hi:[1,0]
    v_cvt_pk_bf16_f32 v64, v72, v73
    v_cvt_pk_bf16_f32 v65, v74, v75
    ds_write_b64 v27, v[70:71] offset:0
    s_waitcnt lgkmcnt(10)
    buffer_store_dwordx4 v[100:103], v50, s[16:19], s33 offen offset:1024
    v_accvgpr_read_b32 v84, a156
    v_accvgpr_read_b32 v85, a157
    v_accvgpr_read_b32 v86, a158
    v_accvgpr_read_b32 v87, a159
    v_pk_mul_f32 v[80:81], v[80:81], v[54:55] op_sel:[0,0] op_sel_hi:[1,0]
    v_pk_mul_f32 v[82:83], v[82:83], v[54:55] op_sel:[0,0] op_sel_hi:[1,0]
    v_cvt_pk_bf16_f32 v66, v76, v77
    v_cvt_pk_bf16_f32 v67, v78, v79
    ds_write_b64 v61, v[64:65] offset:128
    v_accvgpr_read_b32 v72, a160
    v_accvgpr_read_b32 v73, a161
    v_accvgpr_read_b32 v74, a162
    v_accvgpr_read_b32 v75, a163
    v_pk_mul_f32 v[84:85], v[84:85], v[54:55] op_sel:[0,0] op_sel_hi:[1,0]
    v_pk_mul_f32 v[86:87], v[86:87], v[54:55] op_sel:[0,0] op_sel_hi:[1,0]
    v_cvt_pk_bf16_f32 v68, v80, v81
    v_cvt_pk_bf16_f32 v69, v82, v83
    ds_write_b64 v25, v[66:67] offset:128
    s_waitcnt lgkmcnt(11)
    buffer_store_dwordx4 v[104:107], v50, s[16:19], s33 offen offset:2048
    v_accvgpr_read_b32 v76, a164
    v_accvgpr_read_b32 v77, a165
    v_accvgpr_read_b32 v78, a166
    v_accvgpr_read_b32 v79, a167
    v_pk_mul_f32 v[72:73], v[72:73], v[54:55] op_sel:[0,0] op_sel_hi:[1,0]
    v_pk_mul_f32 v[74:75], v[74:75], v[54:55] op_sel:[0,0] op_sel_hi:[1,0]
    v_cvt_pk_bf16_f32 v70, v84, v85
    v_cvt_pk_bf16_f32 v71, v86, v87
    ds_write_b64 v26, v[68:69] offset:128
    v_accvgpr_read_b32 v80, a168
    v_accvgpr_read_b32 v81, a169
    v_accvgpr_read_b32 v82, a170
    v_accvgpr_read_b32 v83, a171
    v_pk_mul_f32 v[76:77], v[76:77], v[54:55] op_sel:[0,0] op_sel_hi:[1,0]
    v_pk_mul_f32 v[78:79], v[78:79], v[54:55] op_sel:[0,0] op_sel_hi:[1,0]
    v_cvt_pk_bf16_f32 v64, v72, v73
    v_cvt_pk_bf16_f32 v65, v74, v75
    ds_write_b64 v27, v[70:71] offset:128
    s_waitcnt lgkmcnt(12)
    buffer_store_dwordx4 v[108:111], v50, s[16:19], s33 offen offset:3072
    v_accvgpr_read_b32 v84, a172
    v_accvgpr_read_b32 v85, a173
    v_accvgpr_read_b32 v86, a174
    v_accvgpr_read_b32 v87, a175
    v_pk_mul_f32 v[80:81], v[80:81], v[54:55] op_sel:[0,0] op_sel_hi:[1,0]
    v_pk_mul_f32 v[82:83], v[82:83], v[54:55] op_sel:[0,0] op_sel_hi:[1,0]
    v_cvt_pk_bf16_f32 v66, v76, v77
    v_cvt_pk_bf16_f32 v67, v78, v79
    ds_write_b64 v61, v[64:65] offset:256
    v_accvgpr_read_b32 v72, a176
    v_accvgpr_read_b32 v73, a177
    v_accvgpr_read_b32 v74, a178
    v_accvgpr_read_b32 v75, a179
    v_pk_mul_f32 v[84:85], v[84:85], v[54:55] op_sel:[0,0] op_sel_hi:[1,0]
    v_pk_mul_f32 v[86:87], v[86:87], v[54:55] op_sel:[0,0] op_sel_hi:[1,0]
    v_cvt_pk_bf16_f32 v68, v80, v81
    v_cvt_pk_bf16_f32 v69, v82, v83
    ds_write_b64 v25, v[66:67] offset:256
    s_waitcnt lgkmcnt(13)
    buffer_store_dwordx4 v[112:115], v50, s[16:19], s34 offen offset:0
    v_accvgpr_read_b32 v76, a180
    v_accvgpr_read_b32 v77, a181
    v_accvgpr_read_b32 v78, a182
    v_accvgpr_read_b32 v79, a183
    v_pk_mul_f32 v[72:73], v[72:73], v[54:55] op_sel:[0,0] op_sel_hi:[1,0]
    v_pk_mul_f32 v[74:75], v[74:75], v[54:55] op_sel:[0,0] op_sel_hi:[1,0]
    v_cvt_pk_bf16_f32 v70, v84, v85
    v_cvt_pk_bf16_f32 v71, v86, v87
    ds_write_b64 v26, v[68:69] offset:256
    v_accvgpr_read_b32 v80, a184
    v_accvgpr_read_b32 v81, a185
    v_accvgpr_read_b32 v82, a186
    v_accvgpr_read_b32 v83, a187
    v_pk_mul_f32 v[76:77], v[76:77], v[54:55] op_sel:[0,0] op_sel_hi:[1,0]
    v_pk_mul_f32 v[78:79], v[78:79], v[54:55] op_sel:[0,0] op_sel_hi:[1,0]
    v_cvt_pk_bf16_f32 v64, v72, v73
    v_cvt_pk_bf16_f32 v65, v74, v75
    ds_write_b64 v27, v[70:71] offset:256
    s_waitcnt lgkmcnt(14)
    buffer_store_dwordx4 v[116:119], v50, s[16:19], s34 offen offset:1024
    v_accvgpr_read_b32 v84, a188
    v_accvgpr_read_b32 v85, a189
    v_accvgpr_read_b32 v86, a190
    v_accvgpr_read_b32 v87, a191
    v_pk_mul_f32 v[80:81], v[80:81], v[54:55] op_sel:[0,0] op_sel_hi:[1,0]
    v_pk_mul_f32 v[82:83], v[82:83], v[54:55] op_sel:[0,0] op_sel_hi:[1,0]
    v_cvt_pk_bf16_f32 v66, v76, v77
    v_cvt_pk_bf16_f32 v67, v78, v79
    ds_write_b64 v61, v[64:65] offset:384
    v_accvgpr_read_b32 v72, a192
    v_accvgpr_read_b32 v73, a193
    v_accvgpr_read_b32 v74, a194
    v_accvgpr_read_b32 v75, a195
    v_pk_mul_f32 v[84:85], v[84:85], v[54:55] op_sel:[0,0] op_sel_hi:[1,0]
    v_pk_mul_f32 v[86:87], v[86:87], v[54:55] op_sel:[0,0] op_sel_hi:[1,0]
    v_cvt_pk_bf16_f32 v68, v80, v81
    v_cvt_pk_bf16_f32 v69, v82, v83
    ds_write_b64 v25, v[66:67] offset:384
    s_waitcnt lgkmcnt(15)
    buffer_store_dwordx4 v[120:123], v50, s[16:19], s34 offen offset:2048
    v_accvgpr_read_b32 v76, a196
    v_accvgpr_read_b32 v77, a197
    v_accvgpr_read_b32 v78, a198
    v_accvgpr_read_b32 v79, a199
    v_pk_mul_f32 v[72:73], v[72:73], v[54:55] op_sel:[0,1] op_sel_hi:[1,1]
    v_pk_mul_f32 v[74:75], v[74:75], v[54:55] op_sel:[0,1] op_sel_hi:[1,1]
    v_cvt_pk_bf16_f32 v70, v84, v85
    v_cvt_pk_bf16_f32 v71, v86, v87
    ds_write_b64 v26, v[68:69] offset:384
    v_accvgpr_read_b32 v80, a200
    v_accvgpr_read_b32 v81, a201
    v_accvgpr_read_b32 v82, a202
    v_accvgpr_read_b32 v83, a203
    v_pk_mul_f32 v[76:77], v[76:77], v[54:55] op_sel:[0,1] op_sel_hi:[1,1]
    v_pk_mul_f32 v[78:79], v[78:79], v[54:55] op_sel:[0,1] op_sel_hi:[1,1]
    v_cvt_pk_bf16_f32 v64, v72, v73
    v_cvt_pk_bf16_f32 v65, v74, v75
    ds_write_b64 v27, v[70:71] offset:384
    s_waitcnt lgkmcnt(15)
    buffer_store_dwordx4 v[124:127], v50, s[16:19], s34 offen offset:3072
    v_accvgpr_read_b32 v84, a204
    v_accvgpr_read_b32 v85, a205
    v_accvgpr_read_b32 v86, a206
    v_accvgpr_read_b32 v87, a207
    v_pk_mul_f32 v[80:81], v[80:81], v[54:55] op_sel:[0,1] op_sel_hi:[1,1]
    v_pk_mul_f32 v[82:83], v[82:83], v[54:55] op_sel:[0,1] op_sel_hi:[1,1]
    v_cvt_pk_bf16_f32 v66, v76, v77
    v_cvt_pk_bf16_f32 v67, v78, v79
    ds_write_b64 v61, v[64:65] offset:8192
    v_accvgpr_read_b32 v72, a208
    v_accvgpr_read_b32 v73, a209
    v_accvgpr_read_b32 v74, a210
    v_accvgpr_read_b32 v75, a211
    v_pk_mul_f32 v[84:85], v[84:85], v[54:55] op_sel:[0,1] op_sel_hi:[1,1]
    v_pk_mul_f32 v[86:87], v[86:87], v[54:55] op_sel:[0,1] op_sel_hi:[1,1]
    v_cvt_pk_bf16_f32 v68, v80, v81
    v_cvt_pk_bf16_f32 v69, v82, v83
    ds_write_b64 v25, v[66:67] offset:8192
    v_accvgpr_read_b32 v76, a212
    v_accvgpr_read_b32 v77, a213
    v_accvgpr_read_b32 v78, a214
    v_accvgpr_read_b32 v79, a215
    v_pk_mul_f32 v[72:73], v[72:73], v[54:55] op_sel:[0,1] op_sel_hi:[1,1]
    v_pk_mul_f32 v[74:75], v[74:75], v[54:55] op_sel:[0,1] op_sel_hi:[1,1]
    v_cvt_pk_bf16_f32 v70, v84, v85
    v_cvt_pk_bf16_f32 v71, v86, v87
    ds_write_b64 v26, v[68:69] offset:8192
    v_pk_mul_f32 v[76:77], v[76:77], v[54:55] op_sel:[0,1] op_sel_hi:[1,1]
    v_pk_mul_f32 v[78:79], v[78:79], v[54:55] op_sel:[0,1] op_sel_hi:[1,1]
    v_cvt_pk_bf16_f32 v64, v72, v73
    v_cvt_pk_bf16_f32 v65, v74, v75
    ds_write_b64 v27, v[70:71] offset:8192
    v_cvt_pk_bf16_f32 v66, v76, v77
    v_cvt_pk_bf16_f32 v67, v78, v79
    ds_write_b64 v61, v[64:65] offset:8320
    ds_write_b64 v25, v[66:67] offset:8320
    s_add_u32 s74, s28, 16384
    s_mov_b32 s75, 0
    s_mov_b32 s28, s38
    s_mov_b32 s32, s31
    s_add_u32 s30, s32, 262144
    s_mov_b32 s31, 2147483648
    s_mov_b32 s29, s32
    s_add_u32 s22, s32, 32768
    s_add_u32 s23, s32, 16384
    s_waitcnt vmcnt(16)
    v_add_u32 v28, s39, v2
    v_add_u32 v29, s39, v3
    ds_read_b128 a[24:27], v28 offset:16384
    ds_read_b128 a[56:59], v28 offset:18432
    ds_read_b128 a[88:91], v28 offset:20480
    ds_read_b128 a[120:123], v28 offset:22528
    ds_read_b128 a[28:31], v29 offset:16384
    ds_read_b128 a[60:63], v29 offset:18432
    ds_read_b128 a[92:95], v29 offset:20480
    ds_read_b128 a[124:127], v29 offset:22528
    ds_read_b128 v[32:35], v2 offset:0
    ds_read_b128 v[36:39], v2 offset:2048
    ds_read_b128 v[40:43], v3 offset:0
    ds_read_b128 v[44:47], v3 offset:2048
    s_waitcnt lgkmcnt(3)
    v_mfma_f32_16x16x32_bf16 v[88:91], v[32:35], a[96:99], 0
    v_accvgpr_read_b32 v104, a216
    v_accvgpr_read_b32 v105, a217
    v_mfma_f32_16x16x32_bf16 v[80:83], v[32:35], a[64:67], 0
    v_accvgpr_read_b32 v106, a218
    v_accvgpr_read_b32 v107, a219
    v_mfma_f32_16x16x32_bf16 v[72:75], v[32:35], a[32:35], 0
    v_mul_f32 v104, v104, v55
    v_mul_f32 v105, v105, v55
    v_mfma_f32_16x16x32_bf16 v[64:67], v[32:35], a[0:3], 0
    s_waitcnt lgkmcnt(2)
    ds_read_b128 v[32:35], v2 offset:4096
    v_mul_f32 v106, v106, v55
    v_mfma_f32_16x16x32_bf16 v[68:71], v[36:39], a[0:3], 0
    v_mul_f32 v107, v107, v55
    v_cvt_pk_bf16_f32 v116, v104, v105
    v_mfma_f32_16x16x32_bf16 v[76:79], v[36:39], a[32:35], 0
    v_cvt_pk_bf16_f32 v117, v106, v107
    v_accvgpr_read_b32 v108, a220
    v_mfma_f32_16x16x32_bf16 v[84:87], v[36:39], a[64:67], 0
    ds_write_b64 v26, v[116:117] offset:8320
    v_accvgpr_read_b32 v109, a221
    v_mfma_f32_16x16x32_bf16 v[92:95], v[36:39], a[96:99], 0
    s_waitcnt lgkmcnt(3)
    ds_read_b128 v[36:39], v2 offset:6144
    v_accvgpr_read_b32 v110, a222
    v_mfma_f32_16x16x32_bf16 v[88:91], v[40:43], a[100:103], v[88:91]
    v_accvgpr_read_b32 v111, a223
    v_mul_f32 v108, v108, v55
    v_mfma_f32_16x16x32_bf16 v[80:83], v[40:43], a[68:71], v[80:83]
    v_mul_f32 v109, v109, v55
    v_mul_f32 v110, v110, v55
    v_mfma_f32_16x16x32_bf16 v[72:75], v[40:43], a[36:39], v[72:75]
    v_mul_f32 v111, v111, v55
    v_cvt_pk_bf16_f32 v118, v108, v109
    v_mfma_f32_16x16x32_bf16 v[64:67], v[40:43], a[4:7], v[64:67]
    s_waitcnt lgkmcnt(3)
    ds_read_b128 v[40:43], v3 offset:4096
    v_cvt_pk_bf16_f32 v119, v110, v111
    v_mfma_f32_16x16x32_bf16 v[68:71], v[44:47], a[4:7], v[68:71]
    ds_write_b64 v27, v[118:119] offset:8320
    v_accvgpr_read_b32 v96, a224
    v_mfma_f32_16x16x32_bf16 v[76:79], v[44:47], a[36:39], v[76:79]
    v_accvgpr_read_b32 v97, a225
    v_accvgpr_read_b32 v98, a226
    v_mfma_f32_16x16x32_bf16 v[84:87], v[44:47], a[68:71], v[84:87]
    v_accvgpr_read_b32 v99, a227
    v_mul_f32 v96, v96, v55
    v_mfma_f32_16x16x32_bf16 v[92:95], v[44:47], a[100:103], v[92:95]
    s_waitcnt lgkmcnt(4)
    ds_read_b128 v[44:47], v3 offset:6144
    v_mul_f32 v97, v97, v55
    v_mfma_f32_16x16x32_bf16 v[88:91], v[32:35], a[104:107], v[88:91]
    v_mul_f32 v98, v98, v55
    v_mul_f32 v99, v99, v55
    v_mfma_f32_16x16x32_bf16 v[80:83], v[32:35], a[72:75], v[80:83]
    v_cvt_pk_bf16_f32 v112, v96, v97
    v_cvt_pk_bf16_f32 v113, v98, v99
    v_mfma_f32_16x16x32_bf16 v[72:75], v[32:35], a[40:43], v[72:75]
    ds_write_b64 v61, v[112:113] offset:8448
    v_accvgpr_read_b32 v100, a228
    v_mfma_f32_16x16x32_bf16 v[64:67], v[32:35], a[8:11], v[64:67]
    s_waitcnt lgkmcnt(4)
    ds_read_b128 v[32:35], v2 offset:8192
    v_accvgpr_read_b32 v101, a229
    v_mfma_f32_16x16x32_bf16 v[68:71], v[36:39], a[8:11], v[68:71]
    v_accvgpr_read_b32 v102, a230
    v_accvgpr_read_b32 v103, a231
    v_mfma_f32_16x16x32_bf16 v[76:79], v[36:39], a[40:43], v[76:79]
    v_mul_f32 v100, v100, v55
    v_mul_f32 v101, v101, v55
    v_mfma_f32_16x16x32_bf16 v[84:87], v[36:39], a[72:75], v[84:87]
    v_mul_f32 v102, v102, v55
    v_mul_f32 v103, v103, v55
    v_mfma_f32_16x16x32_bf16 v[92:95], v[36:39], a[104:107], v[92:95]
    s_waitcnt lgkmcnt(4)
    ds_read_b128 v[36:39], v2 offset:10240
    v_cvt_pk_bf16_f32 v114, v100, v101
    v_mfma_f32_16x16x32_bf16 v[88:91], v[40:43], a[108:111], v[88:91]
    v_cvt_pk_bf16_f32 v115, v102, v103
    v_accvgpr_read_b32 v104, a232
    v_mfma_f32_16x16x32_bf16 v[80:83], v[40:43], a[76:79], v[80:83]
    ds_write_b64 v25, v[114:115] offset:8448
    v_accvgpr_read_b32 v105, a233
    v_mfma_f32_16x16x32_bf16 v[72:75], v[40:43], a[44:47], v[72:75]
    v_accvgpr_read_b32 v106, a234
    v_accvgpr_read_b32 v107, a235
    v_mfma_f32_16x16x32_bf16 v[64:67], v[40:43], a[12:15], v[64:67]
    s_waitcnt lgkmcnt(4)
    ds_read_b128 v[40:43], v3 offset:8192
    v_mul_f32 v104, v104, v55
    v_mfma_f32_16x16x32_bf16 v[68:71], v[44:47], a[12:15], v[68:71]
    v_mul_f32 v105, v105, v55
    v_mul_f32 v106, v106, v55
    v_mfma_f32_16x16x32_bf16 v[76:79], v[44:47], a[44:47], v[76:79]
    v_mul_f32 v107, v107, v55
    v_cvt_pk_bf16_f32 v116, v104, v105
    v_mfma_f32_16x16x32_bf16 v[84:87], v[44:47], a[76:79], v[84:87]
    v_cvt_pk_bf16_f32 v117, v106, v107
    v_accvgpr_read_b32 v108, a236
    v_mfma_f32_16x16x32_bf16 v[92:95], v[44:47], a[108:111], v[92:95]
    s_waitcnt lgkmcnt(3)
    ds_read_b128 v[44:47], v3 offset:10240
    v_accvgpr_read_b32 v109, a237
    v_mfma_f32_16x16x32_bf16 v[88:91], v[32:35], a[112:115], v[88:91]
    ds_write_b64 v26, v[116:117] offset:8448
    v_accvgpr_read_b32 v110, a238
    v_mfma_f32_16x16x32_bf16 v[80:83], v[32:35], a[80:83], v[80:83]
    v_accvgpr_read_b32 v111, a239
    v_mul_f32 v108, v108, v55
    v_mfma_f32_16x16x32_bf16 v[72:75], v[32:35], a[48:51], v[72:75]
    v_mul_f32 v109, v109, v55
    v_mul_f32 v110, v110, v55
    v_mfma_f32_16x16x32_bf16 v[64:67], v[32:35], a[16:19], v[64:67]
    s_waitcnt lgkmcnt(4)
    ds_read_b128 v[32:35], v2 offset:12288
    v_mul_f32 v111, v111, v55
    v_mfma_f32_16x16x32_bf16 v[68:71], v[36:39], a[16:19], v[68:71]
    v_cvt_pk_bf16_f32 v118, v108, v109
    v_cvt_pk_bf16_f32 v119, v110, v111
    v_mfma_f32_16x16x32_bf16 v[76:79], v[36:39], a[48:51], v[76:79]
    ds_write_b64 v27, v[118:119] offset:8448
    v_accvgpr_read_b32 v96, a240
    v_mfma_f32_16x16x32_bf16 v[84:87], v[36:39], a[80:83], v[84:87]
    v_accvgpr_read_b32 v97, a241
    v_accvgpr_read_b32 v98, a242
    v_mfma_f32_16x16x32_bf16 v[92:95], v[36:39], a[112:115], v[92:95]
    s_waitcnt lgkmcnt(4)
    ds_read_b128 v[36:39], v2 offset:14336
    v_accvgpr_read_b32 v99, a243
    v_mfma_f32_16x16x32_bf16 v[88:91], v[40:43], a[116:119], v[88:91]
    v_mul_f32 v96, v96, v55
    v_mul_f32 v97, v97, v55
    v_mfma_f32_16x16x32_bf16 v[80:83], v[40:43], a[84:87], v[80:83]
    v_mul_f32 v98, v98, v55
    v_mul_f32 v99, v99, v55
    v_mfma_f32_16x16x32_bf16 v[72:75], v[40:43], a[52:55], v[72:75]
    v_cvt_pk_bf16_f32 v112, v96, v97
    v_cvt_pk_bf16_f32 v113, v98, v99
    v_mfma_f32_16x16x32_bf16 v[64:67], v[40:43], a[20:23], v[64:67]
    s_waitcnt lgkmcnt(4)
    ds_read_b128 v[40:43], v3 offset:12288
    v_accvgpr_read_b32 v100, a244
    v_mfma_f32_16x16x32_bf16 v[68:71], v[44:47], a[20:23], v[68:71]
    ds_write_b64 v61, v[112:113] offset:8576
    v_accvgpr_read_b32 v101, a245
    v_mfma_f32_16x16x32_bf16 v[76:79], v[44:47], a[52:55], v[76:79]
    v_accvgpr_read_b32 v102, a246
    v_accvgpr_read_b32 v103, a247
    v_mfma_f32_16x16x32_bf16 v[84:87], v[44:47], a[84:87], v[84:87]
    v_mul_f32 v100, v100, v55
    v_mul_f32 v101, v101, v55
    v_mfma_f32_16x16x32_bf16 v[92:95], v[44:47], a[116:119], v[92:95]
    s_waitcnt lgkmcnt(4)
    ds_read_b128 v[44:47], v3 offset:14336
    v_mul_f32 v102, v102, v55
    v_mfma_f32_16x16x32_bf16 v[88:91], v[32:35], a[120:123], v[88:91]
    v_mul_f32 v103, v103, v55
    v_cvt_pk_bf16_f32 v114, v100, v101
    v_mfma_f32_16x16x32_bf16 v[80:83], v[32:35], a[88:91], v[80:83]
    v_cvt_pk_bf16_f32 v115, v102, v103
    v_accvgpr_read_b32 v104, a248
    v_mfma_f32_16x16x32_bf16 v[72:75], v[32:35], a[56:59], v[72:75]
    ds_write_b64 v25, v[114:115] offset:8576
    v_accvgpr_read_b32 v105, a249
    v_mfma_f32_16x16x32_bf16 v[64:67], v[32:35], a[24:27], v[64:67]
    s_waitcnt lgkmcnt(4)
    ds_read_b128 v[32:35], v2 offset:16384
    v_accvgpr_read_b32 v106, a250
    v_mfma_f32_16x16x32_bf16 v[68:71], v[36:39], a[24:27], v[68:71]
    v_accvgpr_read_b32 v107, a251
    v_mul_f32 v104, v104, v55
    v_mfma_f32_16x16x32_bf16 v[76:79], v[36:39], a[56:59], v[76:79]
    v_mul_f32 v105, v105, v55
    v_mul_f32 v106, v106, v55
    v_mfma_f32_16x16x32_bf16 v[84:87], v[36:39], a[88:91], v[84:87]
    v_mul_f32 v107, v107, v55
    v_cvt_pk_bf16_f32 v116, v104, v105
    v_mfma_f32_16x16x32_bf16 v[92:95], v[36:39], a[120:123], v[92:95]
    s_waitcnt lgkmcnt(4)
    ds_read_b128 v[36:39], v2 offset:18432
    v_cvt_pk_bf16_f32 v117, v106, v107
    v_mfma_f32_16x16x32_bf16 v[88:91], v[40:43], a[124:127], v[88:91]
    ds_write_b64 v26, v[116:117] offset:8576
    v_accvgpr_read_b32 v108, a252
    v_mfma_f32_16x16x32_bf16 v[80:83], v[40:43], a[92:95], v[80:83]
    v_accvgpr_read_b32 v109, a253
    v_accvgpr_read_b32 v110, a254
    v_mfma_f32_16x16x32_bf16 v[72:75], v[40:43], a[60:63], v[72:75]
    v_accvgpr_read_b32 v111, a255
    v_mul_f32 v108, v108, v55
    v_mfma_f32_16x16x32_bf16 v[64:67], v[40:43], a[28:31], v[64:67]
    s_waitcnt lgkmcnt(4)
    ds_read_b128 v[40:43], v3 offset:16384
    v_mul_f32 v109, v109, v55
    v_mfma_f32_16x16x32_bf16 v[68:71], v[44:47], a[28:31], v[68:71]
    v_mul_f32 v110, v110, v55
    v_mul_f32 v111, v111, v55
    v_mfma_f32_16x16x32_bf16 v[76:79], v[44:47], a[60:63], v[76:79]
    v_cvt_pk_bf16_f32 v118, v108, v109
    v_cvt_pk_bf16_f32 v119, v110, v111
    v_mfma_f32_16x16x32_bf16 v[84:87], v[44:47], a[92:95], v[84:87]
    ds_write_b64 v27, v[118:119] offset:8576
    v_mfma_f32_16x16x32_bf16 v[92:95], v[44:47], a[124:127], v[92:95]
    s_waitcnt lgkmcnt(4)
    ds_read_b128 v[44:47], v3 offset:18432
    s_waitcnt lgkmcnt(5)
    v_mfma_f32_16x16x32_bf16 v[120:123], v[32:35], a[96:99], 0
    s_waitcnt vmcnt(24)
    v_mfma_f32_16x16x32_bf16 v[112:115], v[32:35], a[64:67], 0
    s_barrier
    v_mfma_f32_16x16x32_bf16 v[104:107], v[32:35], a[32:35], 0
    v_max3_f32 v18, v64, v65, v66
    v_max3_f32 v19, v72, v73, v74
    v_mfma_f32_16x16x32_bf16 v[96:99], v[32:35], a[0:3], 0
    s_waitcnt lgkmcnt(4)
    ds_read_b128 v[32:35], v2 offset:20480
    v_max3_f32 v20, v80, v81, v82
    v_mfma_f32_16x16x32_bf16 v[100:103], v[36:39], a[0:3], 0
    s_add_u32 m0, s21, 0
    v_max3_f32 v21, v88, v89, v90
    v_max3_f32 v18, v18, v67, v68
    v_mfma_f32_16x16x32_bf16 v[108:111], v[36:39], a[32:35], 0
    buffer_load_dwordx4 v8, s[8:11], s22 offen offset:0 lds
    v_mfma_f32_16x16x32_bf16 v[116:119], v[36:39], a[64:67], 0
    v_max3_f32 v19, v19, v75, v76
    v_max3_f32 v20, v20, v83, v84
    v_mfma_f32_16x16x32_bf16 v[124:127], v[36:39], a[96:99], 0
    s_waitcnt lgkmcnt(3)
    ds_read_b128 v[36:39], v2 offset:22528
    v_max3_f32 v21, v21, v91, v92
    v_mfma_f32_16x16x32_bf16 v[120:123], v[40:43], a[100:103], v[120:123]
    s_add_u32 m0, s21, 3968
    v_max3_f32 v18, v18, v69, v70
    v_max3_f32 v19, v19, v77, v78
    v_mfma_f32_16x16x32_bf16 v[112:115], v[40:43], a[68:71], v[112:115]
    buffer_load_dwordx4 v8, s[8:11], s22 offen offset:128 lds
    v_mfma_f32_16x16x32_bf16 v[104:107], v[40:43], a[36:39], v[104:107]
    v_max3_f32 v20, v20, v85, v86
    v_max3_f32 v21, v21, v93, v94
    v_mfma_f32_16x16x32_bf16 v[96:99], v[40:43], a[4:7], v[96:99]
    s_waitcnt lgkmcnt(2)
    ds_read_b128 v[40:43], v3 offset:20480
    v_max_f32 v18, v18, v71
    v_mfma_f32_16x16x32_bf16 v[100:103], v[44:47], a[4:7], v[100:103]
    s_add_u32 m0, s21, 7936
    v_max_f32 v19, v19, v79
    v_max_f32 v20, v20, v87
    v_mfma_f32_16x16x32_bf16 v[108:111], v[44:47], a[36:39], v[108:111]
    buffer_load_dwordx4 v8, s[8:11], s22 offen offset:256 lds
    v_mfma_f32_16x16x32_bf16 v[116:119], v[44:47], a[68:71], v[116:119]
    v_max_f32 v21, v21, v95
    v_mov_b32 v24, v18
    v_mfma_f32_16x16x32_bf16 v[124:127], v[44:47], a[100:103], v[124:127]
    s_waitcnt lgkmcnt(2)
    ds_read_b128 v[44:47], v3 offset:22528
    v_mov_b32 v25, v19
    v_mfma_f32_16x16x32_bf16 v[120:123], v[32:35], a[104:107], v[120:123]
    s_add_u32 m0, s21, 11904
    v_mov_b32 v26, v20
    v_mov_b32 v27, v21
    v_mfma_f32_16x16x32_bf16 v[112:115], v[32:35], a[72:75], v[112:115]
    buffer_load_dwordx4 v8, s[8:11], s22 offen offset:384 lds
    v_mfma_f32_16x16x32_bf16 v[104:107], v[32:35], a[40:43], v[104:107]
    v_permlane32_swap_b32 v18, v24
    v_mfma_f32_16x16x32_bf16 v[96:99], v[32:35], a[8:11], v[96:99]
    s_waitcnt lgkmcnt(2)
    ds_read_b128 v[32:35], v2 offset:24576
    v_max_f32 v18, v18, v24
    v_mfma_f32_16x16x32_bf16 v[100:103], v[36:39], a[8:11], v[100:103]
    s_add_u32 m0, s21, 49152
    v_permlane32_swap_b32 v19, v25
    v_mfma_f32_16x16x32_bf16 v[108:111], v[36:39], a[40:43], v[108:111]
    buffer_load_dwordx4 v9, s[12:15], s23 offen offset:0 lds
    v_mfma_f32_16x16x32_bf16 v[116:119], v[36:39], a[72:75], v[116:119]
    v_permlane32_swap_b32 v20, v26
    v_mfma_f32_16x16x32_bf16 v[124:127], v[36:39], a[104:107], v[124:127]
    s_waitcnt lgkmcnt(2)
    ds_read_b128 v[36:39], v2 offset:26624
    v_max_f32 v19, v19, v25
    v_mfma_f32_16x16x32_bf16 v[120:123], v[40:43], a[108:111], v[120:123]
    v_xor_b32 v60, s75, v49
    v_max_f32 v20, v20, v26
    v_mfma_f32_16x16x32_bf16 v[112:115], v[40:43], a[76:79], v[112:115]
    ds_read_b128 v[56:59], v60 offset:0
    v_mov_b32 v24, v18
    v_mfma_f32_16x16x32_bf16 v[104:107], v[40:43], a[44:47], v[104:107]
    v_add_u32 v49, 1024, v49
    v_mov_b32 v25, v19
    v_mfma_f32_16x16x32_bf16 v[96:99], v[40:43], a[12:15], v[96:99]
    s_waitcnt lgkmcnt(3)
    ds_read_b128 v[40:43], v3 offset:24576
    v_mov_b32 v26, v20
    v_mfma_f32_16x16x32_bf16 v[100:103], v[44:47], a[12:15], v[100:103]
    s_add_u32 m0, s21, 53120
    v_permlane32_swap_b32 v21, v27
    v_mfma_f32_16x16x32_bf16 v[108:111], v[44:47], a[44:47], v[108:111]
    buffer_load_dwordx4 v9, s[12:15], s23 offen offset:128 lds
    v_mfma_f32_16x16x32_bf16 v[116:119], v[44:47], a[76:79], v[116:119]
    v_max_f32 v21, v21, v27
    v_mov_b32 v27, v21
    v_mfma_f32_16x16x32_bf16 v[124:127], v[44:47], a[108:111], v[124:127]
    s_waitcnt lgkmcnt(3)
    ds_read_b128 v[44:47], v3 offset:26624
    v_mfma_f32_16x16x32_bf16 v[120:123], v[32:35], a[112:115], v[120:123]
    v_permlane16_swap_b32 v18, v24
    v_mfma_f32_16x16x32_bf16 v[112:115], v[32:35], a[80:83], v[112:115]
    s_waitcnt lgkmcnt(2)
    buffer_store_dwordx4 v[56:59], v50, s[16:19], s74 offen offset:0 nt
    v_mfma_f32_16x16x32_bf16 v[104:107], v[32:35], a[48:51], v[104:107]
    s_add_u32 s74, s74, 1024
    v_permlane16_swap_b32 v19, v25
    v_mfma_f32_16x16x32_bf16 v[96:99], v[32:35], a[16:19], v[96:99]
    s_waitcnt lgkmcnt(3)
    ds_read_b128 v[32:35], v2 offset:28672
    v_max_f32 v18, v18, v24
    v_mfma_f32_16x16x32_bf16 v[100:103], v[36:39], a[16:19], v[100:103]
    s_add_u32 s75, s75, 32
    v_permlane16_swap_b32 v20, v26
    v_mfma_f32_16x16x32_bf16 v[108:111], v[36:39], a[48:51], v[108:111]
    s_and_b32 s75, s75, 96
    v_permlane16_swap_b32 v21, v27
    v_mfma_f32_16x16x32_bf16 v[116:119], v[36:39], a[80:83], v[116:119]
    v_max_f32 v19, v19, v25
    v_max_f32 v20, v20, v26
    v_mfma_f32_16x16x32_bf16 v[124:127], v[36:39], a[112:115], v[124:127]
    s_waitcnt lgkmcnt(2)
    ds_read_b128 v[36:39], v2 offset:30720
    v_max_f32 v21, v21, v27
    v_mfma_f32_16x16x32_bf16 v[120:123], v[40:43], a[116:119], v[120:123]
    s_add_u32 m0, s21, 57088
    v_mul_f32 v18, s26, v18
    v_sub_f32 v10, 0, v18
    v_mfma_f32_16x16x32_bf16 v[112:115], v[40:43], a[84:87], v[112:115]
    buffer_load_dwordx4 v9, s[12:15], s23 offen offset:256 lds
    v_mfma_f32_16x16x32_bf16 v[104:107], v[40:43], a[52:55], v[104:107]
    v_mul_f32 v19, s26, v19
    v_sub_f32 v11, 0, v19
    v_mfma_f32_16x16x32_bf16 v[96:99], v[40:43], a[20:23], v[96:99]
    s_waitcnt lgkmcnt(2)
    ds_read_b128 v[40:43], v3 offset:28672
    v_mul_f32 v20, s26, v20
    v_mfma_f32_16x16x32_bf16 v[100:103], v[44:47], a[20:23], v[100:103]
    s_add_u32 m0, s21, 61056
    v_sub_f32 v12, 0, v20
    v_mul_f32 v21, s26, v21
    v_mfma_f32_16x16x32_bf16 v[108:111], v[44:47], a[52:55], v[108:111]
    buffer_load_dwordx4 v9, s[12:15], s23 offen offset:384 lds
    v_mfma_f32_16x16x32_bf16 v[116:119], v[44:47], a[84:87], v[116:119]
    s_add_u32 s22, s22, 16384
    v_sub_f32 v13, 0, v21
    v_fma_f32 v64, v64, s26, v10
    v_mfma_f32_16x16x32_bf16 v[124:127], v[44:47], a[116:119], v[124:127]
    s_waitcnt lgkmcnt(2)
    ds_read_b128 v[44:47], v3 offset:30720
    v_fma_f32 v65, v65, s26, v10
    v_mfma_f32_16x16x32_bf16 v[120:123], v[32:35], a[120:123], v[120:123]
    s_add_u32 s23, s23, 16384
    v_exp_f32 v64, v64
    v_mfma_f32_16x16x32_bf16 v[112:115], v[32:35], a[88:91], v[112:115]
    v_exp_f32 v65, v65
    v_mfma_f32_16x16x32_bf16 v[104:107], v[32:35], a[56:59], v[104:107]
    v_fma_f32 v66, v66, s26, v10
    v_fma_f32 v67, v67, s26, v10
    v_mfma_f32_16x16x32_bf16 v[96:99], v[32:35], a[24:27], v[96:99]
    s_waitcnt lgkmcnt(2)
    ds_read_b64_tr_b16 v[32:33], v4 offset:32768
    v_add_f32 v18, v64, v65
    v_mfma_f32_16x16x32_bf16 v[100:103], v[36:39], a[24:27], v[100:103]
    ds_read_b64_tr_b16 v[34:35], v4 offset:34816
    v_cvt_pk_bf16_f32 v64, v64, v65
    v_mfma_f32_16x16x32_bf16 v[108:111], v[36:39], a[56:59], v[108:111]
    v_exp_f32 v66, v66
    v_mfma_f32_16x16x32_bf16 v[116:119], v[36:39], a[88:91], v[116:119]
    v_exp_f32 v67, v67
    v_mfma_f32_16x16x32_bf16 v[124:127], v[36:39], a[120:123], v[124:127]
    s_waitcnt lgkmcnt(3)
    ds_read_b64_tr_b16 v[36:37], v5 offset:32768
    v_fma_f32 v68, v68, s26, v10
    v_mfma_f32_16x16x32_bf16 v[120:123], v[40:43], a[124:127], v[120:123]
    ds_read_b64_tr_b16 v[38:39], v5 offset:34816
    v_fma_f32 v69, v69, s26, v10
    v_mfma_f32_16x16x32_bf16 v[112:115], v[40:43], a[92:95], v[112:115]
    v_add_f32 v18, v18, v66
    v_add_f32 v18, v18, v67
    v_mfma_f32_16x16x32_bf16 v[104:107], v[40:43], a[60:63], v[104:107]
    v_cvt_pk_bf16_f32 v65, v66, v67
    v_fma_f32 v70, v70, s26, v10
    v_mfma_f32_16x16x32_bf16 v[96:99], v[40:43], a[28:31], v[96:99]
    s_waitcnt lgkmcnt(4)
    ds_read_b64_tr_b16 v[40:41], v6 offset:32768
    v_fma_f32 v71, v71, s26, v10
    v_mfma_f32_16x16x32_bf16 v[100:103], v[44:47], a[28:31], v[100:103]
    ds_read_b64_tr_b16 v[42:43], v6 offset:34816
    v_fma_f32 v72, v72, s26, v11
    v_mfma_f32_16x16x32_bf16 v[108:111], v[44:47], a[60:63], v[108:111]
    v_exp_f32 v68, v68
    v_mfma_f32_16x16x32_bf16 v[116:119], v[44:47], a[92:95], v[116:119]
    v_exp_f32 v69, v69
    v_mfma_f32_16x16x32_bf16 v[124:127], v[44:47], a[124:127], v[124:127]
    s_waitcnt lgkmcnt(4)
    ds_read_b64_tr_b16 v[44:45], v7 offset:32768
    v_add_f32 v18, v18, v68
    v_add_f32 v18, v18, v69
    v_cvt_pk_bf16_f32 v66, v68, v69
    v_exp_f32 v70, v70
    v_exp_f32 v71, v71
    v_fma_f32 v73, v73, s26, v11
    v_add_f32 v18, v18, v70
    v_add_f32 v18, v18, v71
    v_cvt_pk_bf16_f32 v67, v70, v71
    v_exp_f32 v72, v72
    v_exp_f32 v73, v73
    v_fma_f32 v74, v74, s26, v11
    v_fma_f32 v75, v75, s26, v11
    v_add_f32 v19, v72, v73
    v_cvt_pk_bf16_f32 v72, v72, v73
    v_exp_f32 v74, v74
    v_exp_f32 v75, v75
    v_fma_f32 v76, v76, s26, v11
    v_fma_f32 v77, v77, s26, v11
    v_add_f32 v19, v19, v74
    v_add_f32 v19, v19, v75
    v_cvt_pk_bf16_f32 v73, v74, v75
    v_exp_f32 v76, v76
    v_exp_f32 v77, v77
    v_fma_f32 v78, v78, s26, v11
    v_fma_f32 v79, v79, s26, v11
    v_add_f32 v19, v19, v76
    v_add_f32 v19, v19, v77
    v_cvt_pk_bf16_f32 v74, v76, v77
    v_exp_f32 v78, v78
    v_exp_f32 v79, v79
    v_fma_f32 v80, v80, s26, v12
    v_fma_f32 v81, v81, s26, v12
    v_add_f32 v19, v19, v78
    v_add_f32 v19, v19, v79
    v_cvt_pk_bf16_f32 v75, v78, v79
    v_exp_f32 v80, v80
    v_exp_f32 v81, v81
    v_fma_f32 v82, v82, s26, v12
    v_fma_f32 v83, v83, s26, v12
    v_add_f32 v20, v80, v81
    v_cvt_pk_bf16_f32 v80, v80, v81
    v_exp_f32 v82, v82
    v_exp_f32 v83, v83
    v_fma_f32 v84, v84, s26, v12
    v_fma_f32 v85, v85, s26, v12
    v_add_f32 v20, v20, v82
    v_add_f32 v20, v20, v83
    v_cvt_pk_bf16_f32 v81, v82, v83
    v_exp_f32 v84, v84
    v_exp_f32 v85, v85
    v_fma_f32 v86, v86, s26, v12
    v_fma_f32 v87, v87, s26, v12
    v_add_f32 v20, v20, v84
    v_add_f32 v20, v20, v85
    v_cvt_pk_bf16_f32 v82, v84, v85
    v_exp_f32 v86, v86
    v_exp_f32 v87, v87
    v_fma_f32 v88, v88, s26, v13
    v_fma_f32 v89, v89, s26, v13
    v_add_f32 v20, v20, v86
    v_add_f32 v20, v20, v87
    v_cvt_pk_bf16_f32 v83, v86, v87
    v_exp_f32 v88, v88
    v_exp_f32 v89, v89
    v_fma_f32 v90, v90, s26, v13
    v_fma_f32 v91, v91, s26, v13
    v_add_f32 v21, v88, v89
    v_cvt_pk_bf16_f32 v88, v88, v89
    v_exp_f32 v90, v90
    v_exp_f32 v91, v91
    v_fma_f32 v92, v92, s26, v13
    v_fma_f32 v93, v93, s26, v13
    v_add_f32 v21, v21, v90
    v_add_f32 v21, v21, v91
    v_cvt_pk_bf16_f32 v89, v90, v91
    v_exp_f32 v92, v92
    v_exp_f32 v93, v93
    v_fma_f32 v94, v94, s26, v13
    v_fma_f32 v95, v95, s26, v13
    v_add_f32 v21, v21, v92
    v_add_f32 v21, v21, v93
    v_cvt_pk_bf16_f32 v90, v92, v93
    v_exp_f32 v94, v94
    v_exp_f32 v95, v95
    v_add_f32 v21, v21, v94
    v_add_f32 v21, v21, v95
    v_cvt_pk_bf16_f32 v91, v94, v95
    v_mov_b32 v14, v18
    v_mov_b32 v15, v19
    v_mov_b32 v16, v20
    v_mov_b32 v17, v21
    s_add_u32 s29, s29, 16384
    v_mfma_f32_16x16x32_bf16 v[128:131], v[32:35], v[64:67], 0
    ds_read_b64_tr_b16 v[46:47], v7 offset:34816
    v_fma_f32 v96, v96, s26, v10
    v_mfma_f32_16x16x32_bf16 v[192:195], v[32:35], v[72:75], 0
    s_waitcnt vmcnt(5)
    v_fma_f32 v97, v97, s26, v10
    v_mfma_f32_16x16x32_bf16 a[128:131], v[32:35], v[80:83], 0
    s_barrier
    v_mfma_f32_16x16x32_bf16 a[192:195], v[32:35], v[88:91], 0
    s_waitcnt lgkmcnt(4)
    ds_read_b64_tr_b16 v[32:33], v4 offset:36864
    v_mfma_f32_16x16x32_bf16 a[196:199], v[36:39], v[88:91], 0
    ds_read_b64_tr_b16 v[34:35], v4 offset:38912
    v_fma_f32 v98, v98, s26, v10
    v_mfma_f32_16x16x32_bf16 a[132:135], v[36:39], v[80:83], 0
    s_add_u32 m0, s21, 16384
    v_exp_f32 v96, v96
    v_mfma_f32_16x16x32_bf16 v[196:199], v[36:39], v[72:75], 0
    buffer_load_dwordx4 v8, s[8:11], s22 offen offset:0 lds
    v_mfma_f32_16x16x32_bf16 v[132:135], v[36:39], v[64:67], 0
    s_waitcnt lgkmcnt(4)
    ds_read_b64_tr_b16 v[36:37], v5 offset:36864
    v_fma_f32 v99, v99, s26, v10
    v_mfma_f32_16x16x32_bf16 v[136:139], v[40:43], v[64:67], 0
    ds_read_b64_tr_b16 v[38:39], v5 offset:38912
    v_mfma_f32_16x16x32_bf16 v[200:203], v[40:43], v[72:75], 0
    s_add_u32 m0, s21, 20352
    v_exp_f32 v97, v97
    v_mfma_f32_16x16x32_bf16 a[136:139], v[40:43], v[80:83], 0
    buffer_load_dwordx4 v8, s[8:11], s22 offen offset:128 lds
    v_mfma_f32_16x16x32_bf16 a[200:203], v[40:43], v[88:91], 0
    s_waitcnt lgkmcnt(4)
    ds_read_b64_tr_b16 v[40:41], v6 offset:36864
    v_add_f32 v18, v96, v97
    v_mfma_f32_16x16x32_bf16 a[204:207], v[44:47], v[88:91], 0
    ds_read_b64_tr_b16 v[42:43], v6 offset:38912
    v_cvt_pk_bf16_f32 v96, v96, v97
    v_mfma_f32_16x16x32_bf16 a[140:143], v[44:47], v[80:83], 0
    s_add_u32 m0, s21, 24320
    v_exp_f32 v98, v98
    v_mfma_f32_16x16x32_bf16 v[204:207], v[44:47], v[72:75], 0
    buffer_load_dwordx4 v8, s[8:11], s22 offen offset:256 lds
    v_mfma_f32_16x16x32_bf16 v[140:143], v[44:47], v[64:67], 0
    s_waitcnt lgkmcnt(4)
    ds_read_b64_tr_b16 v[44:45], v7 offset:36864
    v_fma_f32 v100, v100, s26, v10
    v_mfma_f32_16x16x32_bf16 v[144:147], v[32:35], v[64:67], 0
    ds_read_b64_tr_b16 v[46:47], v7 offset:38912
    v_fma_f32 v101, v101, s26, v10
    v_mfma_f32_16x16x32_bf16 v[208:211], v[32:35], v[72:75], 0
    s_add_u32 m0, s21, 28288
    v_exp_f32 v99, v99
    v_mfma_f32_16x16x32_bf16 a[144:147], v[32:35], v[80:83], 0
    buffer_load_dwordx4 v8, s[8:11], s22 offen offset:384 lds
    v_mfma_f32_16x16x32_bf16 a[208:211], v[32:35], v[88:91], 0
    s_waitcnt lgkmcnt(4)
    ds_read_b64_tr_b16 v[32:33], v4 offset:40960
    v_add_f32 v18, v18, v98
    v_mfma_f32_16x16x32_bf16 a[212:215], v[36:39], v[88:91], 0
    s_add_u32 s22, s22, 16384
    ds_read_b64_tr_b16 v[34:35], v4 offset:43008
    v_add_f32 v18, v18, v99
    v_mfma_f32_16x16x32_bf16 a[148:151], v[36:39], v[80:83], 0
    s_cmp_eq_u32 s22, s30
    s_cselect_b32 s22, s31, s22
    v_cvt_pk_bf16_f32 v97, v98, v99
    v_mfma_f32_16x16x32_bf16 v[212:215], v[36:39], v[72:75], 0
    v_exp_f32 v100, v100
    v_mfma_f32_16x16x32_bf16 v[148:151], v[36:39], v[64:67], 0
    s_waitcnt lgkmcnt(4)
    ds_read_b64_tr_b16 v[36:37], v5 offset:40960
    v_fma_f32 v102, v102, s26, v10
    v_mfma_f32_16x16x32_bf16 v[152:155], v[40:43], v[64:67], 0
    ds_read_b64_tr_b16 v[38:39], v5 offset:43008
    v_fma_f32 v103, v103, s26, v10
    v_mfma_f32_16x16x32_bf16 v[216:219], v[40:43], v[72:75], 0
    v_exp_f32 v101, v101
    v_mfma_f32_16x16x32_bf16 a[152:155], v[40:43], v[80:83], 0
    v_add_f32 v18, v18, v100
    v_add_f32 v18, v18, v101
    v_mfma_f32_16x16x32_bf16 a[216:219], v[40:43], v[88:91], 0
    s_waitcnt lgkmcnt(4)
    ds_read_b64_tr_b16 v[40:41], v6 offset:40960
    v_cvt_pk_bf16_f32 v98, v100, v101
    v_mfma_f32_16x16x32_bf16 a[220:223], v[44:47], v[88:91], 0
    ds_read_b64_tr_b16 v[42:43], v6 offset:43008
    v_fma_f32 v104, v104, s26, v11
    v_mfma_f32_16x16x32_bf16 a[156:159], v[44:47], v[80:83], 0
    v_exp_f32 v102, v102
    v_mfma_f32_16x16x32_bf16 v[220:223], v[44:47], v[72:75], 0
    v_exp_f32 v103, v103
    v_mfma_f32_16x16x32_bf16 v[156:159], v[44:47], v[64:67], 0
    s_waitcnt lgkmcnt(4)
    ds_read_b64_tr_b16 v[44:45], v7 offset:40960
    v_fma_f32 v105, v105, s26, v11
    v_mfma_f32_16x16x32_bf16 v[160:163], v[32:35], v[64:67], 0
    ds_read_b64_tr_b16 v[46:47], v7 offset:43008
    v_add_f32 v18, v18, v102
    v_mfma_f32_16x16x32_bf16 v[224:227], v[32:35], v[72:75], 0
    v_add_f32 v18, v18, v103
    v_cvt_pk_bf16_f32 v99, v102, v103
    v_mfma_f32_16x16x32_bf16 a[160:163], v[32:35], v[80:83], 0
    v_exp_f32 v104, v104
    v_mfma_f32_16x16x32_bf16 a[224:227], v[32:35], v[88:91], 0
    s_waitcnt lgkmcnt(4)
    ds_read_b64_tr_b16 v[32:33], v4 offset:45056
    v_fma_f32 v106, v106, s26, v11
    v_mfma_f32_16x16x32_bf16 a[228:231], v[36:39], v[88:91], 0
    ds_read_b64_tr_b16 v[34:35], v4 offset:47104
    v_fma_f32 v107, v107, s26, v11
    v_mfma_f32_16x16x32_bf16 a[164:167], v[36:39], v[80:83], 0
    v_exp_f32 v105, v105
    v_mfma_f32_16x16x32_bf16 v[228:231], v[36:39], v[72:75], 0
    v_add_f32 v19, v104, v105
    v_cvt_pk_bf16_f32 v104, v104, v105
    v_mfma_f32_16x16x32_bf16 v[164:167], v[36:39], v[64:67], 0
    s_waitcnt lgkmcnt(4)
    ds_read_b64_tr_b16 v[36:37], v5 offset:45056
    v_fma_f32 v108, v108, s26, v11
    v_mfma_f32_16x16x32_bf16 v[168:171], v[40:43], v[64:67], 0
    ds_read_b64_tr_b16 v[38:39], v5 offset:47104
    v_fma_f32 v109, v109, s26, v11
    v_mfma_f32_16x16x32_bf16 v[232:235], v[40:43], v[72:75], 0
    v_exp_f32 v106, v106
    v_mfma_f32_16x16x32_bf16 a[168:171], v[40:43], v[80:83], 0
    v_exp_f32 v107, v107
    v_mfma_f32_16x16x32_bf16 a[232:235], v[40:43], v[88:91], 0
    s_waitcnt lgkmcnt(4)
    ds_read_b64_tr_b16 v[40:41], v6 offset:45056
    v_add_f32 v19, v19, v106
    v_mfma_f32_16x16x32_bf16 a[236:239], v[44:47], v[88:91], 0
    ds_read_b64_tr_b16 v[42:43], v6 offset:47104
    v_add_f32 v19, v19, v107
    v_mfma_f32_16x16x32_bf16 a[172:175], v[44:47], v[80:83], 0
    v_cvt_pk_bf16_f32 v105, v106, v107
    v_mfma_f32_16x16x32_bf16 v[236:239], v[44:47], v[72:75], 0
    v_exp_f32 v108, v108
    v_mfma_f32_16x16x32_bf16 v[172:175], v[44:47], v[64:67], 0
    s_waitcnt lgkmcnt(4)
    ds_read_b64_tr_b16 v[44:45], v7 offset:45056
    v_fma_f32 v110, v110, s26, v11
    v_mfma_f32_16x16x32_bf16 v[176:179], v[32:35], v[64:67], 0
    ds_read_b64_tr_b16 v[46:47], v7 offset:47104
    v_fma_f32 v111, v111, s26, v11
    v_mfma_f32_16x16x32_bf16 v[240:243], v[32:35], v[72:75], 0
    v_exp_f32 v109, v109
    v_mfma_f32_16x16x32_bf16 a[176:179], v[32:35], v[80:83], 0
    v_add_f32 v19, v19, v108
    v_add_f32 v19, v19, v109
    v_mfma_f32_16x16x32_bf16 a[240:243], v[32:35], v[88:91], 0
    s_waitcnt lgkmcnt(4)
    ds_read_b128 v[32:35], v2 offset:0
    v_cvt_pk_bf16_f32 v106, v108, v109
    v_mfma_f32_16x16x32_bf16 a[244:247], v[36:39], v[88:91], 0
    v_exp_f32 v110, v110
    v_mfma_f32_16x16x32_bf16 a[180:183], v[36:39], v[80:83], 0
    v_exp_f32 v111, v111
    v_mfma_f32_16x16x32_bf16 v[244:247], v[36:39], v[72:75], 0
    v_fma_f32 v112, v112, s26, v12
    v_mfma_f32_16x16x32_bf16 v[180:183], v[36:39], v[64:67], 0
    s_waitcnt lgkmcnt(3)
    ds_read_b128 v[36:39], v2 offset:2048
    v_fma_f32 v113, v113, s26, v12
    v_mfma_f32_16x16x32_bf16 v[184:187], v[40:43], v[64:67], 0
    v_add_f32 v19, v19, v110
    v_mfma_f32_16x16x32_bf16 v[248:251], v[40:43], v[72:75], 0
    v_mfma_f32_16x16x32_bf16 a[184:187], v[40:43], v[80:83], 0
    v_add_f32 v19, v19, v111
    v_mfma_f32_16x16x32_bf16 a[248:251], v[40:43], v[88:91], 0
    s_waitcnt lgkmcnt(2)
    ds_read_b128 v[40:43], v3 offset:0
    v_cvt_pk_bf16_f32 v107, v110, v111
    v_mfma_f32_16x16x32_bf16 a[252:255], v[44:47], v[88:91], 0
    v_exp_f32 v112, v112
    v_mfma_f32_16x16x32_bf16 a[188:191], v[44:47], v[80:83], 0
    v_exp_f32 v113, v113
    v_mfma_f32_16x16x32_bf16 v[252:255], v[44:47], v[72:75], 0
    v_fma_f32 v114, v114, s26, v12
    v_mfma_f32_16x16x32_bf16 v[188:191], v[44:47], v[64:67], 0
    s_waitcnt lgkmcnt(2)
    ds_read_b128 v[44:47], v3 offset:2048
    s_mov_b32 s24, 7
.p2align 6
L_loop1:
    v_mfma_f32_16x16x32_bf16 v[88:91], v[32:35], a[96:99], 0
    s_waitcnt vmcnt(4)
    v_fma_f32 v115, v115, s26, v12
    v_add_f32 v20, v112, v113
    v_mfma_f32_16x16x32_bf16 v[80:83], v[32:35], a[64:67], 0
    s_barrier
    v_mfma_f32_16x16x32_bf16 v[72:75], v[32:35], a[32:35], 0
    v_cvt_pk_bf16_f32 v112, v112, v113
    v_mfma_f32_16x16x32_bf16 v[64:67], v[32:35], a[0:3], 0
    s_waitcnt lgkmcnt(2)
    ds_read_b128 v[32:35], v2 offset:4096
    v_mfma_f32_16x16x32_bf16 v[68:71], v[36:39], a[0:3], 0
    s_add_u32 m0, s21, 32768
    v_exp_f32 v114, v114
    v_mfma_f32_16x16x32_bf16 v[76:79], v[36:39], a[32:35], 0
    buffer_load_dwordx4 v9, s[12:15], s23 offen offset:0 lds
    v_mfma_f32_16x16x32_bf16 v[84:87], v[36:39], a[64:67], 0
    v_exp_f32 v115, v115
    v_mfma_f32_16x16x32_bf16 v[92:95], v[36:39], a[96:99], 0
    s_waitcnt lgkmcnt(2)
    ds_read_b128 v[36:39], v2 offset:6144
    v_fma_f32 v116, v116, s26, v12
    v_mfma_f32_16x16x32_bf16 v[88:91], v[40:43], a[100:103], v[88:91]
    s_add_u32 m0, s21, 36736
    v_fma_f32 v117, v117, s26, v12
    v_add_f32 v20, v20, v114
    v_mfma_f32_16x16x32_bf16 v[80:83], v[40:43], a[68:71], v[80:83]
    buffer_load_dwordx4 v9, s[12:15], s23 offen offset:128 lds
    v_mfma_f32_16x16x32_bf16 v[72:75], v[40:43], a[36:39], v[72:75]
    v_add_f32 v20, v20, v115
    v_cvt_pk_bf16_f32 v113, v114, v115
    v_mfma_f32_16x16x32_bf16 v[64:67], v[40:43], a[4:7], v[64:67]
    s_waitcnt lgkmcnt(2)
    ds_read_b128 v[40:43], v3 offset:4096
    v_mfma_f32_16x16x32_bf16 v[68:71], v[44:47], a[4:7], v[68:71]
    s_add_u32 m0, s21, 40704
    v_exp_f32 v116, v116
    v_mfma_f32_16x16x32_bf16 v[76:79], v[44:47], a[36:39], v[76:79]
    buffer_load_dwordx4 v9, s[12:15], s23 offen offset:256 lds
    v_mfma_f32_16x16x32_bf16 v[84:87], v[44:47], a[68:71], v[84:87]
    v_exp_f32 v117, v117
    v_mfma_f32_16x16x32_bf16 v[92:95], v[44:47], a[100:103], v[92:95]
    s_waitcnt lgkmcnt(2)
    ds_read_b128 v[44:47], v3 offset:6144
    v_fma_f32 v118, v118, s26, v12
    v_mfma_f32_16x16x32_bf16 v[88:91], v[32:35], a[104:107], v[88:91]
    s_add_u32 m0, s21, 44672
    v_fma_f32 v119, v119, s26, v12
    v_add_f32 v20, v20, v116
    v_mfma_f32_16x16x32_bf16 v[80:83], v[32:35], a[72:75], v[80:83]
    buffer_load_dwordx4 v9, s[12:15], s23 offen offset:384 lds
    v_mfma_f32_16x16x32_bf16 v[72:75], v[32:35], a[40:43], v[72:75]
    s_add_u32 s23, s23, 16384
    v_add_f32 v20, v20, v117
    v_cvt_pk_bf16_f32 v114, v116, v117
    v_mfma_f32_16x16x32_bf16 v[64:67], v[32:35], a[8:11], v[64:67]
    s_waitcnt lgkmcnt(2)
    ds_read_b128 v[32:35], v2 offset:8192
    v_fma_f32 v120, v120, s26, v13
    v_mfma_f32_16x16x32_bf16 v[68:71], v[36:39], a[8:11], v[68:71]
    s_cmp_eq_u32 s23, s30
    s_cselect_b32 s23, s31, s23
    v_fma_f32 v121, v121, s26, v13
    v_mfma_f32_16x16x32_bf16 v[76:79], v[36:39], a[40:43], v[76:79]
    v_exp_f32 v118, v118
    v_mfma_f32_16x16x32_bf16 v[84:87], v[36:39], a[72:75], v[84:87]
    v_exp_f32 v119, v119
    v_mfma_f32_16x16x32_bf16 v[92:95], v[36:39], a[104:107], v[92:95]
    s_waitcnt lgkmcnt(2)
    ds_read_b128 v[36:39], v2 offset:10240
    v_add_f32 v20, v20, v118
    v_mfma_f32_16x16x32_bf16 v[88:91], v[40:43], a[108:111], v[88:91]
    v_xor_b32 v60, s75, v49
    v_add_f32 v20, v20, v119
    v_mfma_f32_16x16x32_bf16 v[80:83], v[40:43], a[76:79], v[80:83]
    ds_read_b128 v[56:59], v60 offset:0
    v_cvt_pk_bf16_f32 v115, v118, v119
    v_mfma_f32_16x16x32_bf16 v[72:75], v[40:43], a[44:47], v[72:75]
    v_add_u32 v49, 1024, v49
    v_mfma_f32_16x16x32_bf16 v[64:67], v[40:43], a[12:15], v[64:67]
    s_waitcnt lgkmcnt(3)
    ds_read_b128 v[40:43], v3 offset:8192
    v_fma_f32 v122, v122, s26, v13
    v_mfma_f32_16x16x32_bf16 v[68:71], v[44:47], a[12:15], v[68:71]
    v_exp_f32 v120, v120
    v_mfma_f32_16x16x32_bf16 v[76:79], v[44:47], a[44:47], v[76:79]
    v_exp_f32 v121, v121
    v_mfma_f32_16x16x32_bf16 v[84:87], v[44:47], a[76:79], v[84:87]
    v_fma_f32 v123, v123, s26, v13
    v_add_f32 v21, v120, v121
    v_mfma_f32_16x16x32_bf16 v[92:95], v[44:47], a[108:111], v[92:95]
    s_waitcnt lgkmcnt(3)
    ds_read_b128 v[44:47], v3 offset:10240
    v_cvt_pk_bf16_f32 v120, v120, v121
    v_mfma_f32_16x16x32_bf16 v[88:91], v[32:35], a[112:115], v[88:91]
    v_exp_f32 v122, v122
    v_mfma_f32_16x16x32_bf16 v[80:83], v[32:35], a[80:83], v[80:83]
    s_waitcnt lgkmcnt(2)
    buffer_store_dwordx4 v[56:59], v50, s[16:19], s74 offen offset:0 nt
    v_mfma_f32_16x16x32_bf16 v[72:75], v[32:35], a[48:51], v[72:75]
    s_add_u32 s74, s74, 1024
    v_exp_f32 v123, v123
    v_mfma_f32_16x16x32_bf16 v[64:67], v[32:35], a[16:19], v[64:67]
    s_waitcnt lgkmcnt(3)
    ds_read_b128 v[32:35], v2 offset:12288
    v_fma_f32 v124, v124, s26, v13
    v_mfma_f32_16x16x32_bf16 v[68:71], v[36:39], a[16:19], v[68:71]
    s_add_u32 s75, s75, 32
    v_fma_f32 v125, v125, s26, v13
    v_add_f32 v21, v21, v122
    v_mfma_f32_16x16x32_bf16 v[76:79], v[36:39], a[48:51], v[76:79]
    s_and_b32 s75, s75, 96
    v_add_f32 v21, v21, v123
    v_mfma_f32_16x16x32_bf16 v[84:87], v[36:39], a[80:83], v[84:87]
    v_cvt_pk_bf16_f32 v121, v122, v123
    v_mfma_f32_16x16x32_bf16 v[92:95], v[36:39], a[112:115], v[92:95]
    s_waitcnt lgkmcnt(2)
    ds_read_b128 v[36:39], v2 offset:14336
    v_mfma_f32_16x16x32_bf16 v[88:91], v[40:43], a[116:119], v[88:91]
    v_exp_f32 v124, v124
    v_mfma_f32_16x16x32_bf16 v[80:83], v[40:43], a[84:87], v[80:83]
    v_exp_f32 v125, v125
    v_mfma_f32_16x16x32_bf16 v[72:75], v[40:43], a[52:55], v[72:75]
    v_fma_f32 v126, v126, s26, v13
    v_fma_f32 v127, v127, s26, v13
    v_mfma_f32_16x16x32_bf16 v[64:67], v[40:43], a[20:23], v[64:67]
    s_waitcnt lgkmcnt(2)
    ds_read_b128 v[40:43], v3 offset:12288
    v_add_f32 v21, v21, v124
    v_mfma_f32_16x16x32_bf16 v[68:71], v[44:47], a[20:23], v[68:71]
    v_add_f32 v21, v21, v125
    v_add_f32 v22, v18, v19
    v_mfma_f32_16x16x32_bf16 v[76:79], v[44:47], a[52:55], v[76:79]
    v_cvt_pk_bf16_f32 v122, v124, v125
    v_mfma_f32_16x16x32_bf16 v[84:87], v[44:47], a[84:87], v[84:87]
    v_exp_f32 v126, v126
    v_mfma_f32_16x16x32_bf16 v[92:95], v[44:47], a[116:119], v[92:95]
    s_waitcnt lgkmcnt(2)
    ds_read_b128 v[44:47], v3 offset:14336
    v_mfma_f32_16x16x32_bf16 v[88:91], v[32:35], a[120:123], v[88:91]
    v_exp_f32 v127, v127
    v_mfma_f32_16x16x32_bf16 v[80:83], v[32:35], a[88:91], v[80:83]
    v_add_f32 v21, v21, v126
    v_add_f32 v21, v21, v127
    v_mfma_f32_16x16x32_bf16 v[72:75], v[32:35], a[56:59], v[72:75]
    v_cvt_pk_bf16_f32 v123, v126, v127
    v_add_f32 v23, v20, v21
    v_mfma_f32_16x16x32_bf16 v[64:67], v[32:35], a[24:27], v[64:67]
    s_waitcnt lgkmcnt(2)
    ds_read_b64_tr_b16 v[32:33], v4 offset:49152
    v_add_f32 v22, v22, v23
    v_mfma_f32_16x16x32_bf16 v[68:71], v[36:39], a[24:27], v[68:71]
    ds_read_b64_tr_b16 v[34:35], v4 offset:51200
    v_cmp_nge_f32 vcc, s27, v22
    v_mfma_f32_16x16x32_bf16 v[76:79], v[36:39], a[56:59], v[76:79]
    v_mfma_f32_16x16x32_bf16 v[84:87], v[36:39], a[88:91], v[84:87]
    s_cbranch_vccnz L_stub_it1a
L_ret_it1a:
    v_mfma_f32_16x16x32_bf16 v[92:95], v[36:39], a[120:123], v[92:95]
    s_waitcnt lgkmcnt(3)
    ds_read_b64_tr_b16 v[36:37], v5 offset:49152
    v_add_f32 v14, v14, v18
    v_mfma_f32_16x16x32_bf16 v[88:91], v[40:43], a[124:127], v[88:91]
    s_add_u32 s29, s29, 16384
    ds_read_b64_tr_b16 v[38:39], v5 offset:51200
    v_add_f32 v15, v15, v19
    v_mfma_f32_16x16x32_bf16 v[80:83], v[40:43], a[92:95], v[80:83]
    v_add_f32 v16, v16, v20
    v_add_f32 v17, v17, v21
    v_mfma_f32_16x16x32_bf16 v[72:75], v[40:43], a[60:63], v[72:75]
    v_mfma_f32_16x16x32_bf16 v[64:67], v[40:43], a[28:31], v[64:67]
    s_waitcnt lgkmcnt(4)
    ds_read_b64_tr_b16 v[40:41], v6 offset:49152
    v_mfma_f32_16x16x32_bf16 v[68:71], v[44:47], a[28:31], v[68:71]
    ds_read_b64_tr_b16 v[42:43], v6 offset:51200
    v_mfma_f32_16x16x32_bf16 v[76:79], v[44:47], a[60:63], v[76:79]
    v_mfma_f32_16x16x32_bf16 v[84:87], v[44:47], a[92:95], v[84:87]
    v_mfma_f32_16x16x32_bf16 v[92:95], v[44:47], a[124:127], v[92:95]
    s_waitcnt lgkmcnt(4)
    ds_read_b64_tr_b16 v[44:45], v7 offset:49152
    v_mfma_f32_16x16x32_bf16 v[128:131], v[32:35], v[96:99], v[128:131]
    ds_read_b64_tr_b16 v[46:47], v7 offset:51200
    v_fma_f32 v64, v64, s26, v10
    v_mfma_f32_16x16x32_bf16 v[192:195], v[32:35], v[104:107], v[192:195]
    s_waitcnt vmcnt(5)
    v_fma_f32 v65, v65, s26, v10
    v_mfma_f32_16x16x32_bf16 a[128:131], v[32:35], v[112:115], a[128:131]
    s_barrier
    v_mfma_f32_16x16x32_bf16 a[192:195], v[32:35], v[120:123], a[192:195]
    s_waitcnt lgkmcnt(4)
    ds_read_b64_tr_b16 v[32:33], v4 offset:53248
    v_mfma_f32_16x16x32_bf16 a[196:199], v[36:39], v[120:123], a[196:199]
    ds_read_b64_tr_b16 v[34:35], v4 offset:55296
    v_fma_f32 v66, v66, s26, v10
    v_mfma_f32_16x16x32_bf16 a[132:135], v[36:39], v[112:115], a[132:135]
    s_add_u32 m0, s21, 0
    v_exp_f32 v64, v64
    v_mfma_f32_16x16x32_bf16 v[196:199], v[36:39], v[104:107], v[196:199]
    buffer_load_dwordx4 v8, s[8:11], s22 offen offset:0 lds
    v_mfma_f32_16x16x32_bf16 v[132:135], v[36:39], v[96:99], v[132:135]
    s_waitcnt lgkmcnt(4)
    ds_read_b64_tr_b16 v[36:37], v5 offset:53248
    v_fma_f32 v67, v67, s26, v10
    v_mfma_f32_16x16x32_bf16 v[136:139], v[40:43], v[96:99], v[136:139]
    ds_read_b64_tr_b16 v[38:39], v5 offset:55296
    v_mfma_f32_16x16x32_bf16 v[200:203], v[40:43], v[104:107], v[200:203]
    s_add_u32 m0, s21, 3968
    v_exp_f32 v65, v65
    v_mfma_f32_16x16x32_bf16 a[136:139], v[40:43], v[112:115], a[136:139]
    buffer_load_dwordx4 v8, s[8:11], s22 offen offset:128 lds
    v_mfma_f32_16x16x32_bf16 a[200:203], v[40:43], v[120:123], a[200:203]
    s_waitcnt lgkmcnt(4)
    ds_read_b64_tr_b16 v[40:41], v6 offset:53248
    v_add_f32 v18, v64, v65
    v_mfma_f32_16x16x32_bf16 a[204:207], v[44:47], v[120:123], a[204:207]
    ds_read_b64_tr_b16 v[42:43], v6 offset:55296
    v_cvt_pk_bf16_f32 v64, v64, v65
    v_mfma_f32_16x16x32_bf16 a[140:143], v[44:47], v[112:115], a[140:143]
    s_add_u32 m0, s21, 7936
    v_exp_f32 v66, v66
    v_mfma_f32_16x16x32_bf16 v[204:207], v[44:47], v[104:107], v[204:207]
    buffer_load_dwordx4 v8, s[8:11], s22 offen offset:256 lds
    v_mfma_f32_16x16x32_bf16 v[140:143], v[44:47], v[96:99], v[140:143]
    s_waitcnt lgkmcnt(4)
    ds_read_b64_tr_b16 v[44:45], v7 offset:53248
    v_fma_f32 v68, v68, s26, v10
    v_mfma_f32_16x16x32_bf16 v[144:147], v[32:35], v[96:99], v[144:147]
    ds_read_b64_tr_b16 v[46:47], v7 offset:55296
    v_fma_f32 v69, v69, s26, v10
    v_mfma_f32_16x16x32_bf16 v[208:211], v[32:35], v[104:107], v[208:211]
    s_add_u32 m0, s21, 11904
    v_exp_f32 v67, v67
    v_mfma_f32_16x16x32_bf16 a[144:147], v[32:35], v[112:115], a[144:147]
    buffer_load_dwordx4 v8, s[8:11], s22 offen offset:384 lds
    v_mfma_f32_16x16x32_bf16 a[208:211], v[32:35], v[120:123], a[208:211]
    s_waitcnt lgkmcnt(4)
    ds_read_b64_tr_b16 v[32:33], v4 offset:57344
    v_add_f32 v18, v18, v66
    v_mfma_f32_16x16x32_bf16 a[212:215], v[36:39], v[120:123], a[212:215]
    s_add_u32 s22, s22, 16384
    ds_read_b64_tr_b16 v[34:35], v4 offset:59392
    v_add_f32 v18, v18, v67
    v_mfma_f32_16x16x32_bf16 a[148:151], v[36:39], v[112:115], a[148:151]
    s_cmp_eq_u32 s22, s30
    s_cselect_b32 s22, s31, s22
    v_cvt_pk_bf16_f32 v65, v66, v67
    v_mfma_f32_16x16x32_bf16 v[212:215], v[36:39], v[104:107], v[212:215]
    v_exp_f32 v68, v68
    v_mfma_f32_16x16x32_bf16 v[148:151], v[36:39], v[96:99], v[148:151]
    s_waitcnt lgkmcnt(4)
    ds_read_b64_tr_b16 v[36:37], v5 offset:57344
    v_fma_f32 v70, v70, s26, v10
    v_mfma_f32_16x16x32_bf16 v[152:155], v[40:43], v[96:99], v[152:155]
    ds_read_b64_tr_b16 v[38:39], v5 offset:59392
    v_fma_f32 v71, v71, s26, v10
    v_mfma_f32_16x16x32_bf16 v[216:219], v[40:43], v[104:107], v[216:219]
    v_exp_f32 v69, v69
    v_mfma_f32_16x16x32_bf16 a[152:155], v[40:43], v[112:115], a[152:155]
    v_add_f32 v18, v18, v68
    v_add_f32 v18, v18, v69
    v_mfma_f32_16x16x32_bf16 a[216:219], v[40:43], v[120:123], a[216:219]
    s_waitcnt lgkmcnt(4)
    ds_read_b64_tr_b16 v[40:41], v6 offset:57344
    v_cvt_pk_bf16_f32 v66, v68, v69
    v_mfma_f32_16x16x32_bf16 a[220:223], v[44:47], v[120:123], a[220:223]
    ds_read_b64_tr_b16 v[42:43], v6 offset:59392
    v_fma_f32 v72, v72, s26, v11
    v_mfma_f32_16x16x32_bf16 a[156:159], v[44:47], v[112:115], a[156:159]
    v_exp_f32 v70, v70
    v_mfma_f32_16x16x32_bf16 v[220:223], v[44:47], v[104:107], v[220:223]
    v_exp_f32 v71, v71
    v_mfma_f32_16x16x32_bf16 v[156:159], v[44:47], v[96:99], v[156:159]
    s_waitcnt lgkmcnt(4)
    ds_read_b64_tr_b16 v[44:45], v7 offset:57344
    v_fma_f32 v73, v73, s26, v11
    v_mfma_f32_16x16x32_bf16 v[160:163], v[32:35], v[96:99], v[160:163]
    ds_read_b64_tr_b16 v[46:47], v7 offset:59392
    v_add_f32 v18, v18, v70
    v_mfma_f32_16x16x32_bf16 v[224:227], v[32:35], v[104:107], v[224:227]
    v_add_f32 v18, v18, v71
    v_cvt_pk_bf16_f32 v67, v70, v71
    v_mfma_f32_16x16x32_bf16 a[160:163], v[32:35], v[112:115], a[160:163]
    v_exp_f32 v72, v72
    v_mfma_f32_16x16x32_bf16 a[224:227], v[32:35], v[120:123], a[224:227]
    s_waitcnt lgkmcnt(4)
    ds_read_b64_tr_b16 v[32:33], v4 offset:61440
    v_fma_f32 v74, v74, s26, v11
    v_mfma_f32_16x16x32_bf16 a[228:231], v[36:39], v[120:123], a[228:231]
    ds_read_b64_tr_b16 v[34:35], v4 offset:63488
    v_fma_f32 v75, v75, s26, v11
    v_mfma_f32_16x16x32_bf16 a[164:167], v[36:39], v[112:115], a[164:167]
    v_exp_f32 v73, v73
    v_mfma_f32_16x16x32_bf16 v[228:231], v[36:39], v[104:107], v[228:231]
    v_add_f32 v19, v72, v73
    v_cvt_pk_bf16_f32 v72, v72, v73
    v_mfma_f32_16x16x32_bf16 v[164:167], v[36:39], v[96:99], v[164:167]
    s_waitcnt lgkmcnt(4)
    ds_read_b64_tr_b16 v[36:37], v5 offset:61440
    v_fma_f32 v76, v76, s26, v11
    v_mfma_f32_16x16x32_bf16 v[168:171], v[40:43], v[96:99], v[168:171]
    ds_read_b64_tr_b16 v[38:39], v5 offset:63488
    v_fma_f32 v77, v77, s26, v11
    v_mfma_f32_16x16x32_bf16 v[232:235], v[40:43], v[104:107], v[232:235]
    v_exp_f32 v74, v74
    v_mfma_f32_16x16x32_bf16 a[168:171], v[40:43], v[112:115], a[168:171]
    v_exp_f32 v75, v75
    v_mfma_f32_16x16x32_bf16 a[232:235], v[40:43], v[120:123], a[232:235]
    s_waitcnt lgkmcnt(4)
    ds_read_b64_tr_b16 v[40:41], v6 offset:61440
    v_add_f32 v19, v19, v74
    v_mfma_f32_16x16x32_bf16 a[236:239], v[44:47], v[120:123], a[236:239]
    ds_read_b64_tr_b16 v[42:43], v6 offset:63488
    v_add_f32 v19, v19, v75
    v_mfma_f32_16x16x32_bf16 a[172:175], v[44:47], v[112:115], a[172:175]
    v_cvt_pk_bf16_f32 v73, v74, v75
    v_mfma_f32_16x16x32_bf16 v[236:239], v[44:47], v[104:107], v[236:239]
    v_exp_f32 v76, v76
    v_mfma_f32_16x16x32_bf16 v[172:175], v[44:47], v[96:99], v[172:175]
    s_waitcnt lgkmcnt(4)
    ds_read_b64_tr_b16 v[44:45], v7 offset:61440
    v_fma_f32 v78, v78, s26, v11
    v_mfma_f32_16x16x32_bf16 v[176:179], v[32:35], v[96:99], v[176:179]
    ds_read_b64_tr_b16 v[46:47], v7 offset:63488
    v_fma_f32 v79, v79, s26, v11
    v_mfma_f32_16x16x32_bf16 v[240:243], v[32:35], v[104:107], v[240:243]
    v_exp_f32 v77, v77
    v_mfma_f32_16x16x32_bf16 a[176:179], v[32:35], v[112:115], a[176:179]
    v_add_f32 v19, v19, v76
    v_add_f32 v19, v19, v77
    v_mfma_f32_16x16x32_bf16 a[240:243], v[32:35], v[120:123], a[240:243]
    s_waitcnt lgkmcnt(4)
    ds_read_b128 v[32:35], v2 offset:16384
    v_cvt_pk_bf16_f32 v74, v76, v77
    v_mfma_f32_16x16x32_bf16 a[244:247], v[36:39], v[120:123], a[244:247]
    v_exp_f32 v78, v78
    v_mfma_f32_16x16x32_bf16 a[180:183], v[36:39], v[112:115], a[180:183]
    v_exp_f32 v79, v79
    v_mfma_f32_16x16x32_bf16 v[244:247], v[36:39], v[104:107], v[244:247]
    v_fma_f32 v80, v80, s26, v12
    v_mfma_f32_16x16x32_bf16 v[180:183], v[36:39], v[96:99], v[180:183]
    s_waitcnt lgkmcnt(3)
    ds_read_b128 v[36:39], v2 offset:18432
    v_fma_f32 v81, v81, s26, v12
    v_mfma_f32_16x16x32_bf16 v[184:187], v[40:43], v[96:99], v[184:187]
    v_add_f32 v19, v19, v78
    v_mfma_f32_16x16x32_bf16 v[248:251], v[40:43], v[104:107], v[248:251]
    v_mfma_f32_16x16x32_bf16 a[184:187], v[40:43], v[112:115], a[184:187]
    v_add_f32 v19, v19, v79
    v_mfma_f32_16x16x32_bf16 a[248:251], v[40:43], v[120:123], a[248:251]
    s_waitcnt lgkmcnt(2)
    ds_read_b128 v[40:43], v3 offset:16384
    v_cvt_pk_bf16_f32 v75, v78, v79
    v_mfma_f32_16x16x32_bf16 a[252:255], v[44:47], v[120:123], a[252:255]
    v_exp_f32 v80, v80
    v_mfma_f32_16x16x32_bf16 a[188:191], v[44:47], v[112:115], a[188:191]
    v_exp_f32 v81, v81
    v_mfma_f32_16x16x32_bf16 v[252:255], v[44:47], v[104:107], v[252:255]
    v_fma_f32 v82, v82, s26, v12
    v_mfma_f32_16x16x32_bf16 v[188:191], v[44:47], v[96:99], v[188:191]
    s_waitcnt lgkmcnt(2)
    ds_read_b128 v[44:47], v3 offset:18432
    v_mfma_f32_16x16x32_bf16 v[120:123], v[32:35], a[96:99], 0
    s_waitcnt vmcnt(5)
    v_fma_f32 v83, v83, s26, v12
    v_add_f32 v20, v80, v81
    v_mfma_f32_16x16x32_bf16 v[112:115], v[32:35], a[64:67], 0
    s_barrier
    v_mfma_f32_16x16x32_bf16 v[104:107], v[32:35], a[32:35], 0
    v_cvt_pk_bf16_f32 v80, v80, v81
    v_mfma_f32_16x16x32_bf16 v[96:99], v[32:35], a[0:3], 0
    s_waitcnt lgkmcnt(2)
    ds_read_b128 v[32:35], v2 offset:20480
    v_mfma_f32_16x16x32_bf16 v[100:103], v[36:39], a[0:3], 0
    s_add_u32 m0, s21, 49152
    v_exp_f32 v82, v82
    v_mfma_f32_16x16x32_bf16 v[108:111], v[36:39], a[32:35], 0
    buffer_load_dwordx4 v9, s[12:15], s23 offen offset:0 lds
    v_mfma_f32_16x16x32_bf16 v[116:119], v[36:39], a[64:67], 0
    v_exp_f32 v83, v83
    v_mfma_f32_16x16x32_bf16 v[124:127], v[36:39], a[96:99], 0
    s_waitcnt lgkmcnt(2)
    ds_read_b128 v[36:39], v2 offset:22528
    v_fma_f32 v84, v84, s26, v12
    v_mfma_f32_16x16x32_bf16 v[120:123], v[40:43], a[100:103], v[120:123]
    s_add_u32 m0, s21, 53120
    v_fma_f32 v85, v85, s26, v12
    v_add_f32 v20, v20, v82
    v_mfma_f32_16x16x32_bf16 v[112:115], v[40:43], a[68:71], v[112:115]
    buffer_load_dwordx4 v9, s[12:15], s23 offen offset:128 lds
    v_mfma_f32_16x16x32_bf16 v[104:107], v[40:43], a[36:39], v[104:107]
    v_add_f32 v20, v20, v83
    v_cvt_pk_bf16_f32 v81, v82, v83
    v_mfma_f32_16x16x32_bf16 v[96:99], v[40:43], a[4:7], v[96:99]
    s_waitcnt lgkmcnt(2)
    ds_read_b128 v[40:43], v3 offset:20480
    v_mfma_f32_16x16x32_bf16 v[100:103], v[44:47], a[4:7], v[100:103]
    s_add_u32 m0, s21, 57088
    v_exp_f32 v84, v84
    v_mfma_f32_16x16x32_bf16 v[108:111], v[44:47], a[36:39], v[108:111]
    buffer_load_dwordx4 v9, s[12:15], s23 offen offset:256 lds
    v_mfma_f32_16x16x32_bf16 v[116:119], v[44:47], a[68:71], v[116:119]
    v_exp_f32 v85, v85
    v_mfma_f32_16x16x32_bf16 v[124:127], v[44:47], a[100:103], v[124:127]
    s_waitcnt lgkmcnt(2)
    ds_read_b128 v[44:47], v3 offset:22528
    v_fma_f32 v86, v86, s26, v12
    v_mfma_f32_16x16x32_bf16 v[120:123], v[32:35], a[104:107], v[120:123]
    s_add_u32 m0, s21, 61056
    v_fma_f32 v87, v87, s26, v12
    v_add_f32 v20, v20, v84
    v_mfma_f32_16x16x32_bf16 v[112:115], v[32:35], a[72:75], v[112:115]
    buffer_load_dwordx4 v9, s[12:15], s23 offen offset:384 lds
    v_mfma_f32_16x16x32_bf16 v[104:107], v[32:35], a[40:43], v[104:107]
    s_add_u32 s23, s23, 16384
    v_add_f32 v20, v20, v85
    v_cvt_pk_bf16_f32 v82, v84, v85
    v_mfma_f32_16x16x32_bf16 v[96:99], v[32:35], a[8:11], v[96:99]
    s_waitcnt lgkmcnt(2)
    ds_read_b128 v[32:35], v2 offset:24576
    v_fma_f32 v88, v88, s26, v13
    v_mfma_f32_16x16x32_bf16 v[100:103], v[36:39], a[8:11], v[100:103]
    s_cmp_eq_u32 s23, s30
    s_cselect_b32 s23, s31, s23
    v_fma_f32 v89, v89, s26, v13
    v_mfma_f32_16x16x32_bf16 v[108:111], v[36:39], a[40:43], v[108:111]
    v_exp_f32 v86, v86
    v_mfma_f32_16x16x32_bf16 v[116:119], v[36:39], a[72:75], v[116:119]
    v_exp_f32 v87, v87
    v_mfma_f32_16x16x32_bf16 v[124:127], v[36:39], a[104:107], v[124:127]
    s_waitcnt lgkmcnt(2)
    ds_read_b128 v[36:39], v2 offset:26624
    v_add_f32 v20, v20, v86
    v_mfma_f32_16x16x32_bf16 v[120:123], v[40:43], a[108:111], v[120:123]
    v_xor_b32 v60, s75, v49
    v_add_f32 v20, v20, v87
    v_mfma_f32_16x16x32_bf16 v[112:115], v[40:43], a[76:79], v[112:115]
    ds_read_b128 v[56:59], v60 offset:0
    v_cvt_pk_bf16_f32 v83, v86, v87
    v_mfma_f32_16x16x32_bf16 v[104:107], v[40:43], a[44:47], v[104:107]
    v_add_u32 v49, 1024, v49
    v_mfma_f32_16x16x32_bf16 v[96:99], v[40:43], a[12:15], v[96:99]
    s_waitcnt lgkmcnt(3)
    ds_read_b128 v[40:43], v3 offset:24576
    v_fma_f32 v90, v90, s26, v13
    v_mfma_f32_16x16x32_bf16 v[100:103], v[44:47], a[12:15], v[100:103]
    v_exp_f32 v88, v88
    v_mfma_f32_16x16x32_bf16 v[108:111], v[44:47], a[44:47], v[108:111]
    v_exp_f32 v89, v89
    v_mfma_f32_16x16x32_bf16 v[116:119], v[44:47], a[76:79], v[116:119]
    v_fma_f32 v91, v91, s26, v13
    v_add_f32 v21, v88, v89
    v_mfma_f32_16x16x32_bf16 v[124:127], v[44:47], a[108:111], v[124:127]
    s_waitcnt lgkmcnt(3)
    ds_read_b128 v[44:47], v3 offset:26624
    v_cvt_pk_bf16_f32 v88, v88, v89
    v_mfma_f32_16x16x32_bf16 v[120:123], v[32:35], a[112:115], v[120:123]
    v_exp_f32 v90, v90
    v_mfma_f32_16x16x32_bf16 v[112:115], v[32:35], a[80:83], v[112:115]
    s_waitcnt lgkmcnt(2)
    buffer_store_dwordx4 v[56:59], v50, s[16:19], s74 offen offset:0 nt
    v_mfma_f32_16x16x32_bf16 v[104:107], v[32:35], a[48:51], v[104:107]
    s_add_u32 s74, s74, 1024
    v_exp_f32 v91, v91
    v_mfma_f32_16x16x32_bf16 v[96:99], v[32:35], a[16:19], v[96:99]
    s_waitcnt lgkmcnt(3)
    ds_read_b128 v[32:35], v2 offset:28672
    v_fma_f32 v92, v92, s26, v13
    v_mfma_f32_16x16x32_bf16 v[100:103], v[36:39], a[16:19], v[100:103]
    s_add_u32 s75, s75, 32
    v_fma_f32 v93, v93, s26, v13
    v_add_f32 v21, v21, v90
    v_mfma_f32_16x16x32_bf16 v[108:111], v[36:39], a[48:51], v[108:111]
    s_and_b32 s75, s75, 96
    v_add_f32 v21, v21, v91
    v_mfma_f32_16x16x32_bf16 v[116:119], v[36:39], a[80:83], v[116:119]
    v_cvt_pk_bf16_f32 v89, v90, v91
    v_mfma_f32_16x16x32_bf16 v[124:127], v[36:39], a[112:115], v[124:127]
    s_waitcnt lgkmcnt(2)
    ds_read_b128 v[36:39], v2 offset:30720
    v_mfma_f32_16x16x32_bf16 v[120:123], v[40:43], a[116:119], v[120:123]
    v_exp_f32 v92, v92
    v_mfma_f32_16x16x32_bf16 v[112:115], v[40:43], a[84:87], v[112:115]
    v_exp_f32 v93, v93
    v_mfma_f32_16x16x32_bf16 v[104:107], v[40:43], a[52:55], v[104:107]
    v_fma_f32 v94, v94, s26, v13
    v_fma_f32 v95, v95, s26, v13
    v_mfma_f32_16x16x32_bf16 v[96:99], v[40:43], a[20:23], v[96:99]
    s_waitcnt lgkmcnt(2)
    ds_read_b128 v[40:43], v3 offset:28672
    v_add_f32 v21, v21, v92
    v_mfma_f32_16x16x32_bf16 v[100:103], v[44:47], a[20:23], v[100:103]
    v_add_f32 v21, v21, v93
    v_add_f32 v22, v18, v19
    v_mfma_f32_16x16x32_bf16 v[108:111], v[44:47], a[52:55], v[108:111]
    v_cvt_pk_bf16_f32 v90, v92, v93
    v_mfma_f32_16x16x32_bf16 v[116:119], v[44:47], a[84:87], v[116:119]
    v_exp_f32 v94, v94
    v_mfma_f32_16x16x32_bf16 v[124:127], v[44:47], a[116:119], v[124:127]
    s_waitcnt lgkmcnt(2)
    ds_read_b128 v[44:47], v3 offset:30720
    v_mfma_f32_16x16x32_bf16 v[120:123], v[32:35], a[120:123], v[120:123]
    v_exp_f32 v95, v95
    v_mfma_f32_16x16x32_bf16 v[112:115], v[32:35], a[88:91], v[112:115]
    v_add_f32 v21, v21, v94
    v_add_f32 v21, v21, v95
    v_mfma_f32_16x16x32_bf16 v[104:107], v[32:35], a[56:59], v[104:107]
    v_cvt_pk_bf16_f32 v91, v94, v95
    v_add_f32 v23, v20, v21
    v_mfma_f32_16x16x32_bf16 v[96:99], v[32:35], a[24:27], v[96:99]
    s_waitcnt lgkmcnt(2)
    ds_read_b64_tr_b16 v[32:33], v4 offset:32768
    v_add_f32 v22, v22, v23
    v_mfma_f32_16x16x32_bf16 v[100:103], v[36:39], a[24:27], v[100:103]
    ds_read_b64_tr_b16 v[34:35], v4 offset:34816
    v_cmp_nge_f32 vcc, s27, v22
    v_mfma_f32_16x16x32_bf16 v[108:111], v[36:39], a[56:59], v[108:111]
    v_mfma_f32_16x16x32_bf16 v[116:119], v[36:39], a[88:91], v[116:119]
    s_cbranch_vccnz L_stub_it1b
L_ret_it1b:
    v_mfma_f32_16x16x32_bf16 v[124:127], v[36:39], a[120:123], v[124:127]
    s_waitcnt lgkmcnt(3)
    ds_read_b64_tr_b16 v[36:37], v5 offset:32768
    v_add_f32 v14, v14, v18
    v_mfma_f32_16x16x32_bf16 v[120:123], v[40:43], a[124:127], v[120:123]
    s_add_u32 s29, s29, 16384
    ds_read_b64_tr_b16 v[38:39], v5 offset:34816
    v_add_f32 v15, v15, v19
    v_mfma_f32_16x16x32_bf16 v[112:115], v[40:43], a[92:95], v[112:115]
    v_add_f32 v16, v16, v20
    v_add_f32 v17, v17, v21
    v_mfma_f32_16x16x32_bf16 v[104:107], v[40:43], a[60:63], v[104:107]
    v_mfma_f32_16x16x32_bf16 v[96:99], v[40:43], a[28:31], v[96:99]
    s_waitcnt lgkmcnt(4)
    ds_read_b64_tr_b16 v[40:41], v6 offset:32768
    v_mfma_f32_16x16x32_bf16 v[100:103], v[44:47], a[28:31], v[100:103]
    ds_read_b64_tr_b16 v[42:43], v6 offset:34816
    v_mfma_f32_16x16x32_bf16 v[108:111], v[44:47], a[60:63], v[108:111]
    v_mfma_f32_16x16x32_bf16 v[116:119], v[44:47], a[92:95], v[116:119]
    v_mfma_f32_16x16x32_bf16 v[124:127], v[44:47], a[124:127], v[124:127]
    s_waitcnt lgkmcnt(4)
    ds_read_b64_tr_b16 v[44:45], v7 offset:32768
    v_mfma_f32_16x16x32_bf16 v[128:131], v[32:35], v[64:67], v[128:131]
    ds_read_b64_tr_b16 v[46:47], v7 offset:34816
    v_fma_f32 v96, v96, s26, v10
    v_mfma_f32_16x16x32_bf16 v[192:195], v[32:35], v[72:75], v[192:195]
    s_waitcnt vmcnt(5)
    v_fma_f32 v97, v97, s26, v10
    v_mfma_f32_16x16x32_bf16 a[128:131], v[32:35], v[80:83], a[128:131]
    s_barrier
    v_mfma_f32_16x16x32_bf16 a[192:195], v[32:35], v[88:91], a[192:195]
    s_waitcnt lgkmcnt(4)
    ds_read_b64_tr_b16 v[32:33], v4 offset:36864
    v_mfma_f32_16x16x32_bf16 a[196:199], v[36:39], v[88:91], a[196:199]
    ds_read_b64_tr_b16 v[34:35], v4 offset:38912
    v_fma_f32 v98, v98, s26, v10
    v_mfma_f32_16x16x32_bf16 a[132:135], v[36:39], v[80:83], a[132:135]
    s_add_u32 m0, s21, 16384
    v_exp_f32 v96, v96
    v_mfma_f32_16x16x32_bf16 v[196:199], v[36:39], v[72:75], v[196:199]
    buffer_load_dwordx4 v8, s[8:11], s22 offen offset:0 lds
    v_mfma_f32_16x16x32_bf16 v[132:135], v[36:39], v[64:67], v[132:135]
    s_waitcnt lgkmcnt(4)
    ds_read_b64_tr_b16 v[36:37], v5 offset:36864
    v_fma_f32 v99, v99, s26, v10
    v_mfma_f32_16x16x32_bf16 v[136:139], v[40:43], v[64:67], v[136:139]
    ds_read_b64_tr_b16 v[38:39], v5 offset:38912
    v_mfma_f32_16x16x32_bf16 v[200:203], v[40:43], v[72:75], v[200:203]
    s_add_u32 m0, s21, 20352
    v_exp_f32 v97, v97
    v_mfma_f32_16x16x32_bf16 a[136:139], v[40:43], v[80:83], a[136:139]
    buffer_load_dwordx4 v8, s[8:11], s22 offen offset:128 lds
    v_mfma_f32_16x16x32_bf16 a[200:203], v[40:43], v[88:91], a[200:203]
    s_waitcnt lgkmcnt(4)
    ds_read_b64_tr_b16 v[40:41], v6 offset:36864
    v_add_f32 v18, v96, v97
    v_mfma_f32_16x16x32_bf16 a[204:207], v[44:47], v[88:91], a[204:207]
    ds_read_b64_tr_b16 v[42:43], v6 offset:38912
    v_cvt_pk_bf16_f32 v96, v96, v97
    v_mfma_f32_16x16x32_bf16 a[140:143], v[44:47], v[80:83], a[140:143]
    s_add_u32 m0, s21, 24320
    v_exp_f32 v98, v98
    v_mfma_f32_16x16x32_bf16 v[204:207], v[44:47], v[72:75], v[204:207]
    buffer_load_dwordx4 v8, s[8:11], s22 offen offset:256 lds
    v_mfma_f32_16x16x32_bf16 v[140:143], v[44:47], v[64:67], v[140:143]
    s_waitcnt lgkmcnt(4)
    ds_read_b64_tr_b16 v[44:45], v7 offset:36864
    v_fma_f32 v100, v100, s26, v10
    v_mfma_f32_16x16x32_bf16 v[144:147], v[32:35], v[64:67], v[144:147]
    ds_read_b64_tr_b16 v[46:47], v7 offset:38912
    v_fma_f32 v101, v101, s26, v10
    v_mfma_f32_16x16x32_bf16 v[208:211], v[32:35], v[72:75], v[208:211]
    s_add_u32 m0, s21, 28288
    v_exp_f32 v99, v99
    v_mfma_f32_16x16x32_bf16 a[144:147], v[32:35], v[80:83], a[144:147]
    buffer_load_dwordx4 v8, s[8:11], s22 offen offset:384 lds
    v_mfma_f32_16x16x32_bf16 a[208:211], v[32:35], v[88:91], a[208:211]
    s_waitcnt lgkmcnt(4)
    ds_read_b64_tr_b16 v[32:33], v4 offset:40960
    v_add_f32 v18, v18, v98
    v_mfma_f32_16x16x32_bf16 a[212:215], v[36:39], v[88:91], a[212:215]
    s_add_u32 s22, s22, 16384
    ds_read_b64_tr_b16 v[34:35], v4 offset:43008
    v_add_f32 v18, v18, v99
    v_mfma_f32_16x16x32_bf16 a[148:151], v[36:39], v[80:83], a[148:151]
    s_cmp_eq_u32 s22, s30
    s_cselect_b32 s22, s31, s22
    v_cvt_pk_bf16_f32 v97, v98, v99
    v_mfma_f32_16x16x32_bf16 v[212:215], v[36:39], v[72:75], v[212:215]
    v_exp_f32 v100, v100
    v_mfma_f32_16x16x32_bf16 v[148:151], v[36:39], v[64:67], v[148:151]
    s_waitcnt lgkmcnt(4)
    ds_read_b64_tr_b16 v[36:37], v5 offset:40960
    v_fma_f32 v102, v102, s26, v10
    v_mfma_f32_16x16x32_bf16 v[152:155], v[40:43], v[64:67], v[152:155]
    ds_read_b64_tr_b16 v[38:39], v5 offset:43008
    v_fma_f32 v103, v103, s26, v10
    v_mfma_f32_16x16x32_bf16 v[216:219], v[40:43], v[72:75], v[216:219]
    v_exp_f32 v101, v101
    v_mfma_f32_16x16x32_bf16 a[152:155], v[40:43], v[80:83], a[152:155]
    v_add_f32 v18, v18, v100
    v_add_f32 v18, v18, v101
    v_mfma_f32_16x16x32_bf16 a[216:219], v[40:43], v[88:91], a[216:219]
    s_waitcnt lgkmcnt(4)
    ds_read_b64_tr_b16 v[40:41], v6 offset:40960
    v_cvt_pk_bf16_f32 v98, v100, v101
    v_mfma_f32_16x16x32_bf16 a[220:223], v[44:47], v[88:91], a[220:223]
    ds_read_b64_tr_b16 v[42:43], v6 offset:43008
    v_fma_f32 v104, v104, s26, v11
    v_mfma_f32_16x16x32_bf16 a[156:159], v[44:47], v[80:83], a[156:159]
    v_exp_f32 v102, v102
    v_mfma_f32_16x16x32_bf16 v[220:223], v[44:47], v[72:75], v[220:223]
    v_exp_f32 v103, v103
    v_mfma_f32_16x16x32_bf16 v[156:159], v[44:47], v[64:67], v[156:159]
    s_waitcnt lgkmcnt(4)
    ds_read_b64_tr_b16 v[44:45], v7 offset:40960
    v_fma_f32 v105, v105, s26, v11
    v_mfma_f32_16x16x32_bf16 v[160:163], v[32:35], v[64:67], v[160:163]
    ds_read_b64_tr_b16 v[46:47], v7 offset:43008
    v_add_f32 v18, v18, v102
    v_mfma_f32_16x16x32_bf16 v[224:227], v[32:35], v[72:75], v[224:227]
    v_add_f32 v18, v18, v103
    v_cvt_pk_bf16_f32 v99, v102, v103
    v_mfma_f32_16x16x32_bf16 a[160:163], v[32:35], v[80:83], a[160:163]
    v_exp_f32 v104, v104
    v_mfma_f32_16x16x32_bf16 a[224:227], v[32:35], v[88:91], a[224:227]
    s_waitcnt lgkmcnt(4)
    ds_read_b64_tr_b16 v[32:33], v4 offset:45056
    v_fma_f32 v106, v106, s26, v11
    v_mfma_f32_16x16x32_bf16 a[228:231], v[36:39], v[88:91], a[228:231]
    ds_read_b64_tr_b16 v[34:35], v4 offset:47104
    v_fma_f32 v107, v107, s26, v11
    v_mfma_f32_16x16x32_bf16 a[164:167], v[36:39], v[80:83], a[164:167]
    v_exp_f32 v105, v105
    v_mfma_f32_16x16x32_bf16 v[228:231], v[36:39], v[72:75], v[228:231]
    v_add_f32 v19, v104, v105
    v_cvt_pk_bf16_f32 v104, v104, v105
    v_mfma_f32_16x16x32_bf16 v[164:167], v[36:39], v[64:67], v[164:167]
    s_waitcnt lgkmcnt(4)
    ds_read_b64_tr_b16 v[36:37], v5 offset:45056
    v_fma_f32 v108, v108, s26, v11
    v_mfma_f32_16x16x32_bf16 v[168:171], v[40:43], v[64:67], v[168:171]
    ds_read_b64_tr_b16 v[38:39], v5 offset:47104
    v_fma_f32 v109, v109, s26, v11
    v_mfma_f32_16x16x32_bf16 v[232:235], v[40:43], v[72:75], v[232:235]
    v_exp_f32 v106, v106
    v_mfma_f32_16x16x32_bf16 a[168:171], v[40:43], v[80:83], a[168:171]
    v_exp_f32 v107, v107
    v_mfma_f32_16x16x32_bf16 a[232:235], v[40:43], v[88:91], a[232:235]
    s_waitcnt lgkmcnt(4)
    ds_read_b64_tr_b16 v[40:41], v6 offset:45056
    v_add_f32 v19, v19, v106
    v_mfma_f32_16x16x32_bf16 a[236:239], v[44:47], v[88:91], a[236:239]
    ds_read_b64_tr_b16 v[42:43], v6 offset:47104
    v_add_f32 v19, v19, v107
    v_mfma_f32_16x16x32_bf16 a[172:175], v[44:47], v[80:83], a[172:175]
    v_cvt_pk_bf16_f32 v105, v106, v107
    v_mfma_f32_16x16x32_bf16 v[236:239], v[44:47], v[72:75], v[236:239]
    v_exp_f32 v108, v108
    v_mfma_f32_16x16x32_bf16 v[172:175], v[44:47], v[64:67], v[172:175]
    s_waitcnt lgkmcnt(4)
    ds_read_b64_tr_b16 v[44:45], v7 offset:45056
    v_fma_f32 v110, v110, s26, v11
    v_mfma_f32_16x16x32_bf16 v[176:179], v[32:35], v[64:67], v[176:179]
    ds_read_b64_tr_b16 v[46:47], v7 offset:47104
    v_fma_f32 v111, v111, s26, v11
    v_mfma_f32_16x16x32_bf16 v[240:243], v[32:35], v[72:75], v[240:243]
    v_exp_f32 v109, v109
    v_mfma_f32_16x16x32_bf16 a[176:179], v[32:35], v[80:83], a[176:179]
    v_add_f32 v19, v19, v108
    v_add_f32 v19, v19, v109
    v_mfma_f32_16x16x32_bf16 a[240:243], v[32:35], v[88:91], a[240:243]
    s_waitcnt lgkmcnt(4)
    ds_read_b128 v[32:35], v2 offset:0
    v_cvt_pk_bf16_f32 v106, v108, v109
    v_mfma_f32_16x16x32_bf16 a[244:247], v[36:39], v[88:91], a[244:247]
    v_exp_f32 v110, v110
    v_mfma_f32_16x16x32_bf16 a[180:183], v[36:39], v[80:83], a[180:183]
    v_exp_f32 v111, v111
    v_mfma_f32_16x16x32_bf16 v[244:247], v[36:39], v[72:75], v[244:247]
    v_fma_f32 v112, v112, s26, v12
    v_mfma_f32_16x16x32_bf16 v[180:183], v[36:39], v[64:67], v[180:183]
    s_waitcnt lgkmcnt(3)
    ds_read_b128 v[36:39], v2 offset:2048
    v_fma_f32 v113, v113, s26, v12
    v_mfma_f32_16x16x32_bf16 v[184:187], v[40:43], v[64:67], v[184:187]
    v_add_f32 v19, v19, v110
    v_mfma_f32_16x16x32_bf16 v[248:251], v[40:43], v[72:75], v[248:251]
    v_mfma_f32_16x16x32_bf16 a[184:187], v[40:43], v[80:83], a[184:187]
    v_add_f32 v19, v19, v111
    v_mfma_f32_16x16x32_bf16 a[248:251], v[40:43], v[88:91], a[248:251]
    s_waitcnt lgkmcnt(2)
    ds_read_b128 v[40:43], v3 offset:0
    v_cvt_pk_bf16_f32 v107, v110, v111
    v_mfma_f32_16x16x32_bf16 a[252:255], v[44:47], v[88:91], a[252:255]
    v_exp_f32 v112, v112
    v_mfma_f32_16x16x32_bf16 a[188:191], v[44:47], v[80:83], a[188:191]
    s_sub_u32 s24, s24, 1
    v_exp_f32 v113, v113
    v_mfma_f32_16x16x32_bf16 v[252:255], v[44:47], v[72:75], v[252:255]
    s_cmp_lg_u32 s24, 0
    v_fma_f32 v114, v114, s26, v12
    v_mfma_f32_16x16x32_bf16 v[188:191], v[44:47], v[64:67], v[188:191]
    s_waitcnt lgkmcnt(2)
    ds_read_b128 v[44:47], v3 offset:2048
    s_cbranch_scc1 L_loop1
L_tail1:
    s_waitcnt lgkmcnt(0)
    s_waitcnt vmcnt(5)
    v_fma_f32 v115, v115, s26, v12
    v_add_f32 v20, v112, v113
    s_barrier
    v_cvt_pk_bf16_f32 v112, v112, v113
    v_exp_f32 v114, v114
    v_exp_f32 v115, v115
    v_fma_f32 v116, v116, s26, v12
    v_fma_f32 v117, v117, s26, v12
    v_add_f32 v20, v20, v114
    v_add_f32 v20, v20, v115
    v_cvt_pk_bf16_f32 v113, v114, v115
    v_exp_f32 v116, v116
    v_exp_f32 v117, v117
    v_fma_f32 v118, v118, s26, v12
    v_fma_f32 v119, v119, s26, v12
    v_add_f32 v20, v20, v116
    v_add_f32 v20, v20, v117
    v_cvt_pk_bf16_f32 v114, v116, v117
    v_fma_f32 v120, v120, s26, v13
    v_fma_f32 v121, v121, s26, v13
    v_exp_f32 v118, v118
    v_exp_f32 v119, v119
    v_add_f32 v20, v20, v118
    v_xor_b32 v60, s75, v49
    v_add_f32 v20, v20, v119
    ds_read_b128 v[56:59], v60 offset:0
    v_cvt_pk_bf16_f32 v115, v118, v119
    v_add_u32 v49, 1024, v49
    v_fma_f32 v122, v122, s26, v13
    v_exp_f32 v120, v120
    v_exp_f32 v121, v121
    v_fma_f32 v123, v123, s26, v13
    v_add_f32 v21, v120, v121
    v_cvt_pk_bf16_f32 v120, v120, v121
    v_exp_f32 v122, v122
    s_waitcnt lgkmcnt(0)
    buffer_store_dwordx4 v[56:59], v50, s[16:19], s74 offen offset:0 nt
    s_add_u32 s74, s74, 1024
    v_exp_f32 v123, v123
    v_fma_f32 v124, v124, s26, v13
    s_add_u32 s75, s75, 32
    v_fma_f32 v125, v125, s26, v13
    v_add_f32 v21, v21, v122
    s_and_b32 s75, s75, 96
    v_add_f32 v21, v21, v123
    v_cvt_pk_bf16_f32 v121, v122, v123
    v_exp_f32 v124, v124
    v_exp_f32 v125, v125
    v_fma_f32 v126, v126, s26, v13
    v_fma_f32 v127, v127, s26, v13
    v_add_f32 v21, v21, v124
    v_add_f32 v21, v21, v125
    v_add_f32 v22, v18, v19
    v_cvt_pk_bf16_f32 v122, v124, v125
    v_exp_f32 v126, v126
    v_exp_f32 v127, v127
    v_add_f32 v21, v21, v126
    v_add_f32 v21, v21, v127
    v_cvt_pk_bf16_f32 v123, v126, v127
    v_add_f32 v23, v20, v21
    v_add_f32 v22, v22, v23
    v_cmp_nge_f32 vcc, s27, v22
    s_nop 0
    s_cbranch_vccnz L_stub_it1i15
L_ret_it1i15:
    v_add_f32 v14, v14, v18
    s_add_u32 s29, s29, 16384
    v_add_f32 v15, v15, v19
    v_add_f32 v16, v16, v20
    v_add_f32 v17, v17, v21
    ds_read_b64_tr_b16 v[32:33], v4 offset:49152
    ds_read_b64_tr_b16 v[34:35], v4 offset:51200
    ds_read_b64_tr_b16 v[36:37], v5 offset:49152
    ds_read_b64_tr_b16 v[38:39], v5 offset:51200
    ds_read_b64_tr_b16 v[40:41], v6 offset:49152
    ds_read_b64_tr_b16 v[42:43], v6 offset:51200
    ds_read_b64_tr_b16 v[44:45], v7 offset:49152
    ds_read_b64_tr_b16 v[46:47], v7 offset:51200
    v_mov_b32 v22, v14
    v_mov_b32 v23, v15
    v_mov_b32 v24, v16
    v_mov_b32 v25, v17
    v_permlane32_swap_b32 v14, v22
    v_permlane32_swap_b32 v15, v23
    v_permlane32_swap_b32 v16, v24
    v_permlane32_swap_b32 v17, v25
    v_add_f32 v14, v14, v22
    v_add_f32 v15, v15, v23
    v_add_f32 v16, v16, v24
    v_add_f32 v17, v17, v25
    v_mov_b32 v22, v14
    v_mov_b32 v23, v15
    v_mov_b32 v24, v16
    v_mov_b32 v25, v17
    v_permlane16_swap_b32 v14, v22
    v_permlane16_swap_b32 v15, v23
    v_permlane16_swap_b32 v16, v24
    v_permlane16_swap_b32 v17, v25
    v_add_f32 v14, v14, v22
    v_add_f32 v15, v15, v23
    v_add_f32 v16, v16, v24
    v_add_f32 v17, v17, v25
    v_rcp_f32 v52, v14
    v_rcp_f32 v53, v15
    v_rcp_f32 v54, v16
    v_rcp_f32 v55, v17
    v_xor_b32 v25, 32, v61
    v_xor_b32 v26, 64, v61
    v_xor_b32 v27, 96, v61
    s_waitcnt lgkmcnt(0)
    v_add_u32 v49, 0xffffc000, v49
    v_xor_b32 v28, 32, v49
    v_xor_b32 v29, 64, v49
    v_xor_b32 v30, 96, v49
    v_mfma_f32_16x16x32_bf16 v[128:131], v[32:35], v[96:99], v[128:131]
    ds_read_b64_tr_b16 v[46:47], v7 offset:51200
    v_mfma_f32_16x16x32_bf16 v[192:195], v[32:35], v[104:107], v[192:195]
    s_waitcnt vmcnt(1)
    v_mfma_f32_16x16x32_bf16 a[128:131], v[32:35], v[112:115], a[128:131]
    s_barrier
    v_mfma_f32_16x16x32_bf16 a[192:195], v[32:35], v[120:123], a[192:195]
    ds_read_b64_tr_b16 v[32:33], v4 offset:53248
    v_mfma_f32_16x16x32_bf16 a[196:199], v[36:39], v[120:123], a[196:199]
    ds_read_b64_tr_b16 v[34:35], v4 offset:55296
    v_mfma_f32_16x16x32_bf16 a[132:135], v[36:39], v[112:115], a[132:135]
    v_mul_f32 v128, v128, v52
    v_mul_f32 v129, v129, v52
    v_mfma_f32_16x16x32_bf16 v[196:199], v[36:39], v[104:107], v[196:199]
    v_mul_f32 v130, v130, v52
    v_mul_f32 v131, v131, v52
    v_mfma_f32_16x16x32_bf16 v[132:135], v[36:39], v[96:99], v[132:135]
    ds_read_b64_tr_b16 v[36:37], v5 offset:53248
    v_cvt_pk_bf16_f32 v64, v128, v129
    v_mfma_f32_16x16x32_bf16 v[136:139], v[40:43], v[96:99], v[136:139]
    ds_read_b64_tr_b16 v[38:39], v5 offset:55296
    v_cvt_pk_bf16_f32 v65, v130, v131
    v_mfma_f32_16x16x32_bf16 v[200:203], v[40:43], v[104:107], v[200:203]
    ds_write_b64 v61, v[64:65] offset:0
    v_mfma_f32_16x16x32_bf16 a[136:139], v[40:43], v[112:115], a[136:139]
    v_mfma_f32_16x16x32_bf16 a[200:203], v[40:43], v[120:123], a[200:203]
    s_waitcnt lgkmcnt(5)
    ds_read_b64_tr_b16 v[40:41], v6 offset:53248
    v_mfma_f32_16x16x32_bf16 a[204:207], v[44:47], v[120:123], a[204:207]
    ds_read_b64_tr_b16 v[42:43], v6 offset:55296
    v_mul_f32 v132, v132, v52
    v_mfma_f32_16x16x32_bf16 a[140:143], v[44:47], v[112:115], a[140:143]
    v_mul_f32 v133, v133, v52
    v_mul_f32 v134, v134, v52
    v_mfma_f32_16x16x32_bf16 v[204:207], v[44:47], v[104:107], v[204:207]
    v_mul_f32 v135, v135, v52
    v_cvt_pk_bf16_f32 v66, v132, v133
    v_mfma_f32_16x16x32_bf16 v[140:143], v[44:47], v[96:99], v[140:143]
    s_waitcnt lgkmcnt(5)
    ds_read_b64_tr_b16 v[44:45], v7 offset:53248
    v_cvt_pk_bf16_f32 v67, v134, v135
    v_mfma_f32_16x16x32_bf16 v[144:147], v[32:35], v[96:99], v[144:147]
    ds_read_b64_tr_b16 v[46:47], v7 offset:55296
    v_mul_f32 v136, v136, v52
    v_mfma_f32_16x16x32_bf16 v[208:211], v[32:35], v[104:107], v[208:211]
    ds_write_b64 v25, v[66:67] offset:0
    v_mul_f32 v137, v137, v52
    v_mfma_f32_16x16x32_bf16 a[144:147], v[32:35], v[112:115], a[144:147]
    v_mul_f32 v138, v138, v52
    v_mul_f32 v139, v139, v52
    v_mfma_f32_16x16x32_bf16 a[208:211], v[32:35], v[120:123], a[208:211]
    s_waitcnt lgkmcnt(6)
    ds_read_b64_tr_b16 v[32:33], v4 offset:57344
    v_cvt_pk_bf16_f32 v68, v136, v137
    v_mfma_f32_16x16x32_bf16 a[212:215], v[36:39], v[120:123], a[212:215]
    ds_read_b64_tr_b16 v[34:35], v4 offset:59392
    v_cvt_pk_bf16_f32 v69, v138, v139
    v_mfma_f32_16x16x32_bf16 a[148:151], v[36:39], v[112:115], a[148:151]
    ds_write_b64 v26, v[68:69] offset:0
    v_mul_f32 v140, v140, v52
    v_mfma_f32_16x16x32_bf16 v[212:215], v[36:39], v[104:107], v[212:215]
    v_mul_f32 v141, v141, v52
    v_mul_f32 v142, v142, v52
    v_mfma_f32_16x16x32_bf16 v[148:151], v[36:39], v[96:99], v[148:151]
    s_waitcnt lgkmcnt(6)
    ds_read_b64_tr_b16 v[36:37], v5 offset:57344
    v_mul_f32 v143, v143, v52
    v_mfma_f32_16x16x32_bf16 v[152:155], v[40:43], v[96:99], v[152:155]
    ds_read_b64_tr_b16 v[38:39], v5 offset:59392
    v_cvt_pk_bf16_f32 v70, v140, v141
    v_mfma_f32_16x16x32_bf16 v[216:219], v[40:43], v[104:107], v[216:219]
    v_cvt_pk_bf16_f32 v71, v142, v143
    v_mul_f32 v144, v144, v52
    v_mfma_f32_16x16x32_bf16 a[152:155], v[40:43], v[112:115], a[152:155]
    ds_write_b64 v27, v[70:71] offset:0
    v_mul_f32 v145, v145, v52
    v_mfma_f32_16x16x32_bf16 a[216:219], v[40:43], v[120:123], a[216:219]
    s_waitcnt lgkmcnt(7)
    ds_read_b64_tr_b16 v[40:41], v6 offset:57344
    v_mul_f32 v146, v146, v52
    v_mfma_f32_16x16x32_bf16 a[220:223], v[44:47], v[120:123], a[220:223]
    ds_read_b64_tr_b16 v[42:43], v6 offset:59392
    v_mul_f32 v147, v147, v52
    v_mfma_f32_16x16x32_bf16 a[156:159], v[44:47], v[112:115], a[156:159]
    v_cvt_pk_bf16_f32 v64, v144, v145
    v_cvt_pk_bf16_f32 v65, v146, v147
    v_mfma_f32_16x16x32_bf16 v[220:223], v[44:47], v[104:107], v[220:223]
    ds_write_b64 v61, v[64:65] offset:128
    v_mul_f32 v148, v148, v52
    v_mfma_f32_16x16x32_bf16 v[156:159], v[44:47], v[96:99], v[156:159]
    s_waitcnt lgkmcnt(7)
    ds_read_b64_tr_b16 v[44:45], v7 offset:57344
    v_mul_f32 v149, v149, v52
    v_mfma_f32_16x16x32_bf16 v[160:163], v[32:35], v[96:99], v[160:163]
    ds_read_b64_tr_b16 v[46:47], v7 offset:59392
    v_mul_f32 v150, v150, v52
    v_mfma_f32_16x16x32_bf16 v[224:227], v[32:35], v[104:107], v[224:227]
    v_mul_f32 v151, v151, v52
    v_cvt_pk_bf16_f32 v66, v148, v149
    v_mfma_f32_16x16x32_bf16 a[160:163], v[32:35], v[112:115], a[160:163]
    v_cvt_pk_bf16_f32 v67, v150, v151
    v_mul_f32 v152, v152, v52
    v_mfma_f32_16x16x32_bf16 a[224:227], v[32:35], v[120:123], a[224:227]
    s_waitcnt lgkmcnt(6)
    ds_read_b64_tr_b16 v[32:33], v4 offset:61440
    v_mul_f32 v153, v153, v52
    v_mfma_f32_16x16x32_bf16 a[228:231], v[36:39], v[120:123], a[228:231]
    ds_read_b64_tr_b16 v[34:35], v4 offset:63488
    v_mul_f32 v154, v154, v52
    v_mfma_f32_16x16x32_bf16 a[164:167], v[36:39], v[112:115], a[164:167]
    ds_write_b64 v25, v[66:67] offset:128
    v_mul_f32 v155, v155, v52
    v_mfma_f32_16x16x32_bf16 v[228:231], v[36:39], v[104:107], v[228:231]
    v_cvt_pk_bf16_f32 v68, v152, v153
    v_cvt_pk_bf16_f32 v69, v154, v155
    v_mfma_f32_16x16x32_bf16 v[164:167], v[36:39], v[96:99], v[164:167]
    s_waitcnt lgkmcnt(6)
    ds_read_b64_tr_b16 v[36:37], v5 offset:61440
    v_mul_f32 v156, v156, v52
    v_mfma_f32_16x16x32_bf16 v[168:171], v[40:43], v[96:99], v[168:171]
    ds_read_b64_tr_b16 v[38:39], v5 offset:63488
    v_mul_f32 v157, v157, v52
    v_mfma_f32_16x16x32_bf16 v[232:235], v[40:43], v[104:107], v[232:235]
    ds_write_b64 v26, v[68:69] offset:128
    v_mul_f32 v158, v158, v52
    v_mfma_f32_16x16x32_bf16 a[168:171], v[40:43], v[112:115], a[168:171]
    v_mul_f32 v159, v159, v52
    v_cvt_pk_bf16_f32 v70, v156, v157
    v_mfma_f32_16x16x32_bf16 a[232:235], v[40:43], v[120:123], a[232:235]
    s_waitcnt lgkmcnt(6)
    ds_read_b64_tr_b16 v[40:41], v6 offset:61440
    v_cvt_pk_bf16_f32 v71, v158, v159
    v_mfma_f32_16x16x32_bf16 a[236:239], v[44:47], v[120:123], a[236:239]
    ds_read_b64_tr_b16 v[42:43], v6 offset:63488
    v_mul_f32 v160, v160, v52
    v_mfma_f32_16x16x32_bf16 a[172:175], v[44:47], v[112:115], a[172:175]
    ds_write_b64 v27, v[70:71] offset:128
    v_mul_f32 v161, v161, v52
    v_mfma_f32_16x16x32_bf16 v[236:239], v[44:47], v[104:107], v[236:239]
    v_mul_f32 v162, v162, v52
    v_mul_f32 v163, v163, v52
    v_mfma_f32_16x16x32_bf16 v[172:175], v[44:47], v[96:99], v[172:175]
    s_waitcnt lgkmcnt(7)
    ds_read_b64_tr_b16 v[44:45], v7 offset:61440
    v_cvt_pk_bf16_f32 v64, v160, v161
    v_mfma_f32_16x16x32_bf16 v[176:179], v[32:35], v[96:99], v[176:179]
    ds_read_b64_tr_b16 v[46:47], v7 offset:63488
    v_cvt_pk_bf16_f32 v65, v162, v163
    v_mfma_f32_16x16x32_bf16 v[240:243], v[32:35], v[104:107], v[240:243]
    ds_write_b64 v61, v[64:65] offset:256
    v_mul_f32 v164, v164, v52
    v_mfma_f32_16x16x32_bf16 a[176:179], v[32:35], v[112:115], a[176:179]
    v_mul_f32 v165, v165, v52
    v_mul_f32 v166, v166, v52
    v_mfma_f32_16x16x32_bf16 a[240:243], v[32:35], v[120:123], a[240:243]
    s_waitcnt lgkmcnt(7)
    v_mul_f32 v167, v167, v52
    v_cvt_pk_bf16_f32 v66, v164, v165
    v_mfma_f32_16x16x32_bf16 a[244:247], v[36:39], v[120:123], a[244:247]
    v_cvt_pk_bf16_f32 v67, v166, v167
    v_mul_f32 v168, v168, v52
    v_mfma_f32_16x16x32_bf16 a[180:183], v[36:39], v[112:115], a[180:183]
    ds_write_b64 v25, v[66:67] offset:256
    v_mul_f32 v169, v169, v52
    v_mfma_f32_16x16x32_bf16 v[244:247], v[36:39], v[104:107], v[244:247]
    v_mul_f32 v170, v170, v52
    v_mul_f32 v171, v171, v52
    v_mfma_f32_16x16x32_bf16 v[180:183], v[36:39], v[96:99], v[180:183]
    s_waitcnt lgkmcnt(5)
    v_cvt_pk_bf16_f32 v68, v168, v169
    v_cvt_pk_bf16_f32 v69, v170, v171
    v_mfma_f32_16x16x32_bf16 v[184:187], v[40:43], v[96:99], v[184:187]
    ds_write_b64 v26, v[68:69] offset:256
    v_mul_f32 v172, v172, v52
    v_mfma_f32_16x16x32_bf16 v[248:251], v[40:43], v[104:107], v[248:251]
    v_mul_f32 v173, v173, v52
    v_mul_f32 v174, v174, v52
    v_mfma_f32_16x16x32_bf16 a[184:187], v[40:43], v[112:115], a[184:187]
    v_mul_f32 v175, v175, v52
    v_cvt_pk_bf16_f32 v70, v172, v173
    v_mfma_f32_16x16x32_bf16 a[248:251], v[40:43], v[120:123], a[248:251]
    s_waitcnt lgkmcnt(3)
    v_cvt_pk_bf16_f32 v71, v174, v175
    v_mul_f32 v176, v176, v52
    v_mfma_f32_16x16x32_bf16 a[252:255], v[44:47], v[120:123], a[252:255]
    ds_write_b64 v27, v[70:71] offset:256
    v_mul_f32 v177, v177, v52
    v_mfma_f32_16x16x32_bf16 a[188:191], v[44:47], v[112:115], a[188:191]
    v_mul_f32 v178, v178, v52
    v_mul_f32 v179, v179, v52
    v_mfma_f32_16x16x32_bf16 v[252:255], v[44:47], v[104:107], v[252:255]
    v_cvt_pk_bf16_f32 v64, v176, v177
    v_cvt_pk_bf16_f32 v65, v178, v179
    v_mfma_f32_16x16x32_bf16 v[188:191], v[44:47], v[96:99], v[188:191]
    s_waitcnt lgkmcnt(13)
    ds_write_b64 v61, v[64:65] offset:384
    v_mul_f32 v180, v180, v52
    s_nop 7
    v_mul_f32 v181, v181, v52
    v_mul_f32 v182, v182, v52
    v_mul_f32 v183, v183, v52
    v_cvt_pk_bf16_f32 v66, v180, v181
    v_cvt_pk_bf16_f32 v67, v182, v183
    ds_write_b64 v25, v[66:67] offset:384
    v_mul_f32 v184, v184, v52
    v_mul_f32 v185, v185, v52
    v_mul_f32 v186, v186, v52
    v_mul_f32 v187, v187, v52
    v_cvt_pk_bf16_f32 v68, v184, v185
    v_cvt_pk_bf16_f32 v69, v186, v187
    ds_write_b64 v26, v[68:69] offset:384
    v_mul_f32 v188, v188, v52
    v_mul_f32 v189, v189, v52
    v_mul_f32 v190, v190, v52
    v_mul_f32 v191, v191, v52
    v_cvt_pk_bf16_f32 v70, v188, v189
    v_cvt_pk_bf16_f32 v71, v190, v191
    ds_write_b64 v27, v[70:71] offset:384
    ds_read_b128 v[96:99], v49 offset:0
    ds_read_b128 v[100:103], v28 offset:1024
    ds_read_b128 v[104:107], v29 offset:2048
    ds_read_b128 v[108:111], v30 offset:3072
    ds_read_b128 v[112:115], v49 offset:4096
    ds_read_b128 v[116:119], v28 offset:5120
    ds_read_b128 v[120:123], v29 offset:6144
    ds_read_b128 v[124:127], v30 offset:7168
    v_pk_mul_f32 v[192:193], v[192:193], v[52:53] op_sel:[0,1] op_sel_hi:[1,1]
    v_pk_mul_f32 v[194:195], v[194:195], v[52:53] op_sel:[0,1] op_sel_hi:[1,1]
    s_add_u32 s33, s28, 0
    s_add_u32 s34, s28, 4096
    s_waitcnt lgkmcnt(7)
    buffer_store_dwordx4 v[96:99], v50, s[16:19], s33 offen offset:0 nt
    v_pk_mul_f32 v[196:197], v[196:197], v[52:53] op_sel:[0,1] op_sel_hi:[1,1]
    v_pk_mul_f32 v[198:199], v[198:199], v[52:53] op_sel:[0,1] op_sel_hi:[1,1]
    v_cvt_pk_bf16_f32 v64, v192, v193
    v_cvt_pk_bf16_f32 v65, v194, v195
    v_pk_mul_f32 v[200:201], v[200:201], v[52:53] op_sel:[0,1] op_sel_hi:[1,1]
    v_pk_mul_f32 v[202:203], v[202:203], v[52:53] op_sel:[0,1] op_sel_hi:[1,1]
    v_cvt_pk_bf16_f32 v66, v196, v197
    v_cvt_pk_bf16_f32 v67, v198, v199
    ds_write_b64 v61, v[64:65] offset:8192
    s_waitcnt lgkmcnt(7)
    buffer_store_dwordx4 v[100:103], v50, s[16:19], s33 offen offset:1024 nt
    v_pk_mul_f32 v[204:205], v[204:205], v[52:53] op_sel:[0,1] op_sel_hi:[1,1]
    v_pk_mul_f32 v[206:207], v[206:207], v[52:53] op_sel:[0,1] op_sel_hi:[1,1]
    v_cvt_pk_bf16_f32 v68, v200, v201
    v_cvt_pk_bf16_f32 v69, v202, v203
    ds_write_b64 v25, v[66:67] offset:8192
    v_pk_mul_f32 v[208:209], v[208:209], v[52:53] op_sel:[0,1] op_sel_hi:[1,1]
    v_pk_mul_f32 v[210:211], v[210:211], v[52:53] op_sel:[0,1] op_sel_hi:[1,1]
    v_cvt_pk_bf16_f32 v70, v204, v205
    v_cvt_pk_bf16_f32 v71, v206, v207
    ds_write_b64 v26, v[68:69] offset:8192
    s_waitcnt lgkmcnt(8)
    buffer_store_dwordx4 v[104:107], v50, s[16:19], s33 offen offset:2048 nt
    v_pk_mul_f32 v[212:213], v[212:213], v[52:53] op_sel:[0,1] op_sel_hi:[1,1]
    v_pk_mul_f32 v[214:215], v[214:215], v[52:53] op_sel:[0,1] op_sel_hi:[1,1]
    v_cvt_pk_bf16_f32 v64, v208, v209
    v_cvt_pk_bf16_f32 v65, v210, v211
    ds_write_b64 v27, v[70:71] offset:8192
    v_pk_mul_f32 v[216:217], v[216:217], v[52:53] op_sel:[0,1] op_sel_hi:[1,1]
    v_pk_mul_f32 v[218:219], v[218:219], v[52:53] op_sel:[0,1] op_sel_hi:[1,1]
    v_cvt_pk_bf16_f32 v66, v212, v213
    v_cvt_pk_bf16_f32 v67, v214, v215
    ds_write_b64 v61, v[64:65] offset:8320
    s_waitcnt lgkmcnt(9)
    buffer_store_dwordx4 v[108:111], v50, s[16:19], s33 offen offset:3072 nt
    v_pk_mul_f32 v[220:221], v[220:221], v[52:53] op_sel:[0,1] op_sel_hi:[1,1]
    v_pk_mul_f32 v[222:223], v[222:223], v[52:53] op_sel:[0,1] op_sel_hi:[1,1]
    v_cvt_pk_bf16_f32 v68, v216, v217
    v_cvt_pk_bf16_f32 v69, v218, v219
    ds_write_b64 v25, v[66:67] offset:8320
    v_pk_mul_f32 v[224:225], v[224:225], v[52:53] op_sel:[0,1] op_sel_hi:[1,1]
    v_pk_mul_f32 v[226:227], v[226:227], v[52:53] op_sel:[0,1] op_sel_hi:[1,1]
    v_cvt_pk_bf16_f32 v70, v220, v221
    v_cvt_pk_bf16_f32 v71, v222, v223
    ds_write_b64 v26, v[68:69] offset:8320
    s_waitcnt lgkmcnt(10)
    buffer_store_dwordx4 v[112:115], v50, s[16:19], s34 offen offset:0 nt
    v_pk_mul_f32 v[228:229], v[228:229], v[52:53] op_sel:[0,1] op_sel_hi:[1,1]
    v_pk_mul_f32 v[230:231], v[230:231], v[52:53] op_sel:[0,1] op_sel_hi:[1,1]
    v_cvt_pk_bf16_f32 v64, v224, v225
    v_cvt_pk_bf16_f32 v65, v226, v227
    ds_write_b64 v27, v[70:71] offset:8320
    v_pk_mul_f32 v[232:233], v[232:233], v[52:53] op_sel:[0,1] op_sel_hi:[1,1]
    v_pk_mul_f32 v[234:235], v[234:235], v[52:53] op_sel:[0,1] op_sel_hi:[1,1]
    v_cvt_pk_bf16_f32 v66, v228, v229
    v_cvt_pk_bf16_f32 v67, v230, v231
    ds_write_b64 v61, v[64:65] offset:8448
    s_waitcnt lgkmcnt(11)
    buffer_store_dwordx4 v[116:119], v50, s[16:19], s34 offen offset:1024 nt
    v_pk_mul_f32 v[236:237], v[236:237], v[52:53] op_sel:[0,1] op_sel_hi:[1,1]
    v_pk_mul_f32 v[238:239], v[238:239], v[52:53] op_sel:[0,1] op_sel_hi:[1,1]
    v_cvt_pk_bf16_f32 v68, v232, v233
    v_cvt_pk_bf16_f32 v69, v234, v235
    ds_write_b64 v25, v[66:67] offset:8448
    v_pk_mul_f32 v[240:241], v[240:241], v[52:53] op_sel:[0,1] op_sel_hi:[1,1]
    v_pk_mul_f32 v[242:243], v[242:243], v[52:53] op_sel:[0,1] op_sel_hi:[1,1]
    v_cvt_pk_bf16_f32 v70, v236, v237
    v_cvt_pk_bf16_f32 v71, v238, v239
    ds_write_b64 v26, v[68:69] offset:8448
    s_waitcnt lgkmcnt(12)
    buffer_store_dwordx4 v[120:123], v50, s[16:19], s34 offen offset:2048 nt
    v_pk_mul_f32 v[244:245], v[244:245], v[52:53] op_sel:[0,1] op_sel_hi:[1,1]
    v_pk_mul_f32 v[246:247], v[246:247], v[52:53] op_sel:[0,1] op_sel_hi:[1,1]
    v_cvt_pk_bf16_f32 v64, v240, v241
    v_cvt_pk_bf16_f32 v65, v242, v243
    ds_write_b64 v27, v[70:71] offset:8448
    v_pk_mul_f32 v[248:249], v[248:249], v[52:53] op_sel:[0,1] op_sel_hi:[1,1]
    v_pk_mul_f32 v[250:251], v[250:251], v[52:53] op_sel:[0,1] op_sel_hi:[1,1]
    v_cvt_pk_bf16_f32 v66, v244, v245
    v_cvt_pk_bf16_f32 v67, v246, v247
    ds_write_b64 v61, v[64:65] offset:8576
    s_waitcnt lgkmcnt(13)
    buffer_store_dwordx4 v[124:127], v50, s[16:19], s34 offen offset:3072 nt
    v_accvgpr_read_b32 v72, a128
    v_accvgpr_read_b32 v73, a129
    v_accvgpr_read_b32 v74, a130
    v_accvgpr_read_b32 v75, a131
    v_pk_mul_f32 v[252:253], v[252:253], v[52:53] op_sel:[0,1] op_sel_hi:[1,1]
    v_pk_mul_f32 v[254:255], v[254:255], v[52:53] op_sel:[0,1] op_sel_hi:[1,1]
    v_cvt_pk_bf16_f32 v68, v248, v249
    v_cvt_pk_bf16_f32 v69, v250, v251
    ds_write_b64 v25, v[66:67] offset:8576
    v_accvgpr_read_b32 v76, a132
    v_accvgpr_read_b32 v77, a133
    v_accvgpr_read_b32 v78, a134
    v_accvgpr_read_b32 v79, a135
    v_pk_mul_f32 v[72:73], v[72:73], v[54:55] op_sel:[0,0] op_sel_hi:[1,0]
    v_pk_mul_f32 v[74:75], v[74:75], v[54:55] op_sel:[0,0] op_sel_hi:[1,0]
    v_cvt_pk_bf16_f32 v70, v252, v253
    v_cvt_pk_bf16_f32 v71, v254, v255
    ds_write_b64 v26, v[68:69] offset:8576
    v_accvgpr_read_b32 v80, a136
    v_accvgpr_read_b32 v81, a137
    v_accvgpr_read_b32 v82, a138
    v_accvgpr_read_b32 v83, a139
    v_pk_mul_f32 v[76:77], v[76:77], v[54:55] op_sel:[0,0] op_sel_hi:[1,0]
    v_pk_mul_f32 v[78:79], v[78:79], v[54:55] op_sel:[0,0] op_sel_hi:[1,0]
    v_cvt_pk_bf16_f32 v64, v72, v73
    v_cvt_pk_bf16_f32 v65, v74, v75
    ds_write_b64 v27, v[70:71] offset:8576
    ds_read_b128 v[96:99], v49 offset:8192
    ds_read_b128 v[100:103], v28 offset:9216
    ds_read_b128 v[104:107], v29 offset:10240
    ds_read_b128 v[108:111], v30 offset:11264
    ds_read_b128 v[112:115], v49 offset:12288
    ds_read_b128 v[116:119], v28 offset:13312
    ds_read_b128 v[120:123], v29 offset:14336
    ds_read_b128 v[124:127], v30 offset:15360
    v_accvgpr_read_b32 v84, a140
    v_accvgpr_read_b32 v85, a141
    v_accvgpr_read_b32 v86, a142
    v_accvgpr_read_b32 v87, a143
    v_pk_mul_f32 v[80:81], v[80:81], v[54:55] op_sel:[0,0] op_sel_hi:[1,0]
    v_pk_mul_f32 v[82:83], v[82:83], v[54:55] op_sel:[0,0] op_sel_hi:[1,0]
    v_cvt_pk_bf16_f32 v66, v76, v77
    v_cvt_pk_bf16_f32 v67, v78, v79
    ds_write_b64 v61, v[64:65] offset:16384
    v_accvgpr_read_b32 v72, a144
    v_accvgpr_read_b32 v73, a145
    v_accvgpr_read_b32 v74, a146
    v_accvgpr_read_b32 v75, a147
    v_pk_mul_f32 v[84:85], v[84:85], v[54:55] op_sel:[0,0] op_sel_hi:[1,0]
    v_pk_mul_f32 v[86:87], v[86:87], v[54:55] op_sel:[0,0] op_sel_hi:[1,0]
    v_cvt_pk_bf16_f32 v68, v80, v81
    v_cvt_pk_bf16_f32 v69, v82, v83
    ds_write_b64 v25, v[66:67] offset:16384
    s_add_u32 s33, s28, 8192
    s_add_u32 s34, s28, 12288
    s_waitcnt lgkmcnt(9)
    buffer_store_dwordx4 v[96:99], v50, s[16:19], s33 offen offset:0 nt
    v_accvgpr_read_b32 v76, a148
    v_accvgpr_read_b32 v77, a149
    v_accvgpr_read_b32 v78, a150
    v_accvgpr_read_b32 v79, a151
    v_pk_mul_f32 v[72:73], v[72:73], v[54:55] op_sel:[0,0] op_sel_hi:[1,0]
    v_pk_mul_f32 v[74:75], v[74:75], v[54:55] op_sel:[0,0] op_sel_hi:[1,0]
    v_cvt_pk_bf16_f32 v70, v84, v85
    v_cvt_pk_bf16_f32 v71, v86, v87
    ds_write_b64 v26, v[68:69] offset:16384
    v_accvgpr_read_b32 v80, a152
    v_accvgpr_read_b32 v81, a153
    v_accvgpr_read_b32 v82, a154
    v_accvgpr_read_b32 v83, a155
    v_pk_mul_f32 v[76:77], v[76:77], v[54:55] op_sel:[0,0] op_sel_hi:[1,0]
    v_pk_mul_f32 v[78:79], v[78:79], v[54:55] op_sel:[0,0] op_sel_hi:[1,0]
    v_cvt_pk_bf16_f32 v64, v72, v73
    v_cvt_pk_bf16_f32 v65, v74, v75
    ds_write_b64 v27, v[70:71] offset:16384
    s_waitcnt lgkmcnt(10)
    buffer_store_dwordx4 v[100:103], v50, s[16:19], s33 offen offset:1024 nt
    v_accvgpr_read_b32 v84, a156
    v_accvgpr_read_b32 v85, a157
    v_accvgpr_read_b32 v86, a158
    v_accvgpr_read_b32 v87, a159
    v_pk_mul_f32 v[80:81], v[80:81], v[54:55] op_sel:[0,0] op_sel_hi:[1,0]
    v_pk_mul_f32 v[82:83], v[82:83], v[54:55] op_sel:[0,0] op_sel_hi:[1,0]
    v_cvt_pk_bf16_f32 v66, v76, v77
    v_cvt_pk_bf16_f32 v67, v78, v79
    ds_write_b64 v61, v[64:65] offset:16512
    v_accvgpr_read_b32 v72, a160
    v_accvgpr_read_b32 v73, a161
    v_accvgpr_read_b32 v74, a162
    v_accvgpr_read_b32 v75, a163
    v_pk_mul_f32 v[84:85], v[84:85], v[54:55] op_sel:[0,0] op_sel_hi:[1,0]
    v_pk_mul_f32 v[86:87], v[86:87], v[54:55] op_sel:[0,0] op_sel_hi:[1,0]
    v_cvt_pk_bf16_f32 v68, v80, v81
    v_cvt_pk_bf16_f32 v69, v82, v83
    ds_write_b64 v25, v[66:67] offset:16512
    s_waitcnt lgkmcnt(11)
    buffer_store_dwordx4 v[104:107], v50, s[16:19], s33 offen offset:2048 nt
    v_accvgpr_read_b32 v76, a164
    v_accvgpr_read_b32 v77, a165
    v_accvgpr_read_b32 v78, a166
    v_accvgpr_read_b32 v79, a167
    v_pk_mul_f32 v[72:73], v[72:73], v[54:55] op_sel:[0,0] op_sel_hi:[1,0]
    v_pk_mul_f32 v[74:75], v[74:75], v[54:55] op_sel:[0,0] op_sel_hi:[1,0]
    v_cvt_pk_bf16_f32 v70, v84, v85
    v_cvt_pk_bf16_f32 v71, v86, v87
    ds_write_b64 v26, v[68:69] offset:16512
    v_accvgpr_read_b32 v80, a168
    v_accvgpr_read_b32 v81, a169
    v_accvgpr_read_b32 v82, a170
    v_accvgpr_read_b32 v83, a171
    v_pk_mul_f32 v[76:77], v[76:77], v[54:55] op_sel:[0,0] op_sel_hi:[1,0]
    v_pk_mul_f32 v[78:79], v[78:79], v[54:55] op_sel:[0,0] op_sel_hi:[1,0]
    v_cvt_pk_bf16_f32 v64, v72, v73
    v_cvt_pk_bf16_f32 v65, v74, v75
    ds_write_b64 v27, v[70:71] offset:16512
    s_waitcnt lgkmcnt(12)
    buffer_store_dwordx4 v[108:111], v50, s[16:19], s33 offen offset:3072 nt
    v_accvgpr_read_b32 v84, a172
    v_accvgpr_read_b32 v85, a173
    v_accvgpr_read_b32 v86, a174
    v_accvgpr_read_b32 v87, a175
    v_pk_mul_f32 v[80:81], v[80:81], v[54:55] op_sel:[0,0] op_sel_hi:[1,0]
    v_pk_mul_f32 v[82:83], v[82:83], v[54:55] op_sel:[0,0] op_sel_hi:[1,0]
    v_cvt_pk_bf16_f32 v66, v76, v77
    v_cvt_pk_bf16_f32 v67, v78, v79
    ds_write_b64 v61, v[64:65] offset:16640
    v_accvgpr_read_b32 v72, a176
    v_accvgpr_read_b32 v73, a177
    v_accvgpr_read_b32 v74, a178
    v_accvgpr_read_b32 v75, a179
    v_pk_mul_f32 v[84:85], v[84:85], v[54:55] op_sel:[0,0] op_sel_hi:[1,0]
    v_pk_mul_f32 v[86:87], v[86:87], v[54:55] op_sel:[0,0] op_sel_hi:[1,0]
    v_cvt_pk_bf16_f32 v68, v80, v81
    v_cvt_pk_bf16_f32 v69, v82, v83
    ds_write_b64 v25, v[66:67] offset:16640
    s_waitcnt lgkmcnt(13)
    buffer_store_dwordx4 v[112:115], v50, s[16:19], s34 offen offset:0 nt
    v_accvgpr_read_b32 v76, a180
    v_accvgpr_read_b32 v77, a181
    v_accvgpr_read_b32 v78, a182
    v_accvgpr_read_b32 v79, a183
    v_pk_mul_f32 v[72:73], v[72:73], v[54:55] op_sel:[0,0] op_sel_hi:[1,0]
    v_pk_mul_f32 v[74:75], v[74:75], v[54:55] op_sel:[0,0] op_sel_hi:[1,0]
    v_cvt_pk_bf16_f32 v70, v84, v85
    v_cvt_pk_bf16_f32 v71, v86, v87
    ds_write_b64 v26, v[68:69] offset:16640
    v_accvgpr_read_b32 v80, a184
    v_accvgpr_read_b32 v81, a185
    v_accvgpr_read_b32 v82, a186
    v_accvgpr_read_b32 v83, a187
    v_pk_mul_f32 v[76:77], v[76:77], v[54:55] op_sel:[0,0] op_sel_hi:[1,0]
    v_pk_mul_f32 v[78:79], v[78:79], v[54:55] op_sel:[0,0] op_sel_hi:[1,0]
    v_cvt_pk_bf16_f32 v64, v72, v73
    v_cvt_pk_bf16_f32 v65, v74, v75
    ds_write_b64 v27, v[70:71] offset:16640
    s_waitcnt lgkmcnt(14)
    buffer_store_dwordx4 v[116:119], v50, s[16:19], s34 offen offset:1024 nt
    v_accvgpr_read_b32 v84, a188
    v_accvgpr_read_b32 v85, a189
    v_accvgpr_read_b32 v86, a190
    v_accvgpr_read_b32 v87, a191
    v_pk_mul_f32 v[80:81], v[80:81], v[54:55] op_sel:[0,0] op_sel_hi:[1,0]
    v_pk_mul_f32 v[82:83], v[82:83], v[54:55] op_sel:[0,0] op_sel_hi:[1,0]
    v_cvt_pk_bf16_f32 v66, v76, v77
    v_cvt_pk_bf16_f32 v67, v78, v79
    ds_write_b64 v61, v[64:65] offset:16768
    v_accvgpr_read_b32 v72, a192
    v_accvgpr_read_b32 v73, a193
    v_accvgpr_read_b32 v74, a194
    v_accvgpr_read_b32 v75, a195
    v_pk_mul_f32 v[84:85], v[84:85], v[54:55] op_sel:[0,0] op_sel_hi:[1,0]
    v_pk_mul_f32 v[86:87], v[86:87], v[54:55] op_sel:[0,0] op_sel_hi:[1,0]
    v_cvt_pk_bf16_f32 v68, v80, v81
    v_cvt_pk_bf16_f32 v69, v82, v83
    ds_write_b64 v25, v[66:67] offset:16768
    s_waitcnt lgkmcnt(15)
    buffer_store_dwordx4 v[120:123], v50, s[16:19], s34 offen offset:2048 nt
    v_accvgpr_read_b32 v76, a196
    v_accvgpr_read_b32 v77, a197
    v_accvgpr_read_b32 v78, a198
    v_accvgpr_read_b32 v79, a199
    v_pk_mul_f32 v[72:73], v[72:73], v[54:55] op_sel:[0,1] op_sel_hi:[1,1]
    v_pk_mul_f32 v[74:75], v[74:75], v[54:55] op_sel:[0,1] op_sel_hi:[1,1]
    v_cvt_pk_bf16_f32 v70, v84, v85
    v_cvt_pk_bf16_f32 v71, v86, v87
    ds_write_b64 v26, v[68:69] offset:16768
    v_accvgpr_read_b32 v80, a200
    v_accvgpr_read_b32 v81, a201
    v_accvgpr_read_b32 v82, a202
    v_accvgpr_read_b32 v83, a203
    v_pk_mul_f32 v[76:77], v[76:77], v[54:55] op_sel:[0,1] op_sel_hi:[1,1]
    v_pk_mul_f32 v[78:79], v[78:79], v[54:55] op_sel:[0,1] op_sel_hi:[1,1]
    v_cvt_pk_bf16_f32 v64, v72, v73
    v_cvt_pk_bf16_f32 v65, v74, v75
    ds_write_b64 v27, v[70:71] offset:16768
    s_waitcnt lgkmcnt(15)
    buffer_store_dwordx4 v[124:127], v50, s[16:19], s34 offen offset:3072 nt
    ds_read_b128 v[96:99], v49 offset:16384
    ds_read_b128 v[100:103], v28 offset:17408
    ds_read_b128 v[104:107], v29 offset:18432
    ds_read_b128 v[108:111], v30 offset:19456
    ds_read_b128 v[112:115], v49 offset:20480
    ds_read_b128 v[116:119], v28 offset:21504
    ds_read_b128 v[120:123], v29 offset:22528
    ds_read_b128 v[124:127], v30 offset:23552
    v_accvgpr_read_b32 v84, a204
    v_accvgpr_read_b32 v85, a205
    v_accvgpr_read_b32 v86, a206
    v_accvgpr_read_b32 v87, a207
    v_pk_mul_f32 v[80:81], v[80:81], v[54:55] op_sel:[0,1] op_sel_hi:[1,1]
    v_pk_mul_f32 v[82:83], v[82:83], v[54:55] op_sel:[0,1] op_sel_hi:[1,1]
    v_cvt_pk_bf16_f32 v66, v76, v77
    v_cvt_pk_bf16_f32 v67, v78, v79
    ds_write_b64 v61, v[64:65] offset:0
    v_accvgpr_read_b32 v72, a208
    v_accvgpr_read_b32 v73, a209
    v_accvgpr_read_b32 v74, a210
    v_accvgpr_read_b32 v75, a211
    v_pk_mul_f32 v[84:85], v[84:85], v[54:55] op_sel:[0,1] op_sel_hi:[1,1]
    v_pk_mul_f32 v[86:87], v[86:87], v[54:55] op_sel:[0,1] op_sel_hi:[1,1]
    v_cvt_pk_bf16_f32 v68, v80, v81
    v_cvt_pk_bf16_f32 v69, v82, v83
    ds_write_b64 v25, v[66:67] offset:0
    s_add_u32 s33, s28, 16384
    s_add_u32 s34, s28, 20480
    s_waitcnt lgkmcnt(9)
    buffer_store_dwordx4 v[96:99], v50, s[16:19], s33 offen offset:0 nt
    v_accvgpr_read_b32 v76, a212
    v_accvgpr_read_b32 v77, a213
    v_accvgpr_read_b32 v78, a214
    v_accvgpr_read_b32 v79, a215
    v_pk_mul_f32 v[72:73], v[72:73], v[54:55] op_sel:[0,1] op_sel_hi:[1,1]
    v_pk_mul_f32 v[74:75], v[74:75], v[54:55] op_sel:[0,1] op_sel_hi:[1,1]
    v_cvt_pk_bf16_f32 v70, v84, v85
    v_cvt_pk_bf16_f32 v71, v86, v87
    ds_write_b64 v26, v[68:69] offset:0
    v_accvgpr_read_b32 v80, a216
    v_accvgpr_read_b32 v81, a217
    v_accvgpr_read_b32 v82, a218
    v_accvgpr_read_b32 v83, a219
    v_pk_mul_f32 v[76:77], v[76:77], v[54:55] op_sel:[0,1] op_sel_hi:[1,1]
    v_pk_mul_f32 v[78:79], v[78:79], v[54:55] op_sel:[0,1] op_sel_hi:[1,1]
    v_cvt_pk_bf16_f32 v64, v72, v73
    v_cvt_pk_bf16_f32 v65, v74, v75
    ds_write_b64 v27, v[70:71] offset:0
    s_waitcnt lgkmcnt(10)
    buffer_store_dwordx4 v[100:103], v50, s[16:19], s33 offen offset:1024 nt
    v_accvgpr_read_b32 v84, a220
    v_accvgpr_read_b32 v85, a221
    v_accvgpr_read_b32 v86, a222
    v_accvgpr_read_b32 v87, a223
    v_pk_mul_f32 v[80:81], v[80:81], v[54:55] op_sel:[0,1] op_sel_hi:[1,1]
    v_pk_mul_f32 v[82:83], v[82:83], v[54:55] op_sel:[0,1] op_sel_hi:[1,1]
    v_cvt_pk_bf16_f32 v66, v76, v77
    v_cvt_pk_bf16_f32 v67, v78, v79
    ds_write_b64 v61, v[64:65] offset:128
    v_accvgpr_read_b32 v72, a224
    v_accvgpr_read_b32 v73, a225
    v_accvgpr_read_b32 v74, a226
    v_accvgpr_read_b32 v75, a227
    v_pk_mul_f32 v[84:85], v[84:85], v[54:55] op_sel:[0,1] op_sel_hi:[1,1]
    v_pk_mul_f32 v[86:87], v[86:87], v[54:55] op_sel:[0,1] op_sel_hi:[1,1]
    v_cvt_pk_bf16_f32 v68, v80, v81
    v_cvt_pk_bf16_f32 v69, v82, v83
    ds_write_b64 v25, v[66:67] offset:128
    s_waitcnt lgkmcnt(11)
    buffer_store_dwordx4 v[104:107], v50, s[16:19], s33 offen offset:2048 nt
    v_accvgpr_read_b32 v76, a228
    v_accvgpr_read_b32 v77, a229
    v_accvgpr_read_b32 v78, a230
    v_accvgpr_read_b32 v79, a231
    v_pk_mul_f32 v[72:73], v[72:73], v[54:55] op_sel:[0,1] op_sel_hi:[1,1]
    v_pk_mul_f32 v[74:75], v[74:75], v[54:55] op_sel:[0,1] op_sel_hi:[1,1]
    v_cvt_pk_bf16_f32 v70, v84, v85
    v_cvt_pk_bf16_f32 v71, v86, v87
    ds_write_b64 v26, v[68:69] offset:128
    v_accvgpr_read_b32 v80, a232
    v_accvgpr_read_b32 v81, a233
    v_accvgpr_read_b32 v82, a234
    v_accvgpr_read_b32 v83, a235
    v_pk_mul_f32 v[76:77], v[76:77], v[54:55] op_sel:[0,1] op_sel_hi:[1,1]
    v_pk_mul_f32 v[78:79], v[78:79], v[54:55] op_sel:[0,1] op_sel_hi:[1,1]
    v_cvt_pk_bf16_f32 v64, v72, v73
    v_cvt_pk_bf16_f32 v65, v74, v75
    ds_write_b64 v27, v[70:71] offset:128
    s_waitcnt lgkmcnt(12)
    buffer_store_dwordx4 v[108:111], v50, s[16:19], s33 offen offset:3072 nt
    v_accvgpr_read_b32 v84, a236
    v_accvgpr_read_b32 v85, a237
    v_accvgpr_read_b32 v86, a238
    v_accvgpr_read_b32 v87, a239
    v_pk_mul_f32 v[80:81], v[80:81], v[54:55] op_sel:[0,1] op_sel_hi:[1,1]
    v_pk_mul_f32 v[82:83], v[82:83], v[54:55] op_sel:[0,1] op_sel_hi:[1,1]
    v_cvt_pk_bf16_f32 v66, v76, v77
    v_cvt_pk_bf16_f32 v67, v78, v79
    ds_write_b64 v61, v[64:65] offset:256
    v_accvgpr_read_b32 v72, a240
    v_accvgpr_read_b32 v73, a241
    v_accvgpr_read_b32 v74, a242
    v_accvgpr_read_b32 v75, a243
    v_pk_mul_f32 v[84:85], v[84:85], v[54:55] op_sel:[0,1] op_sel_hi:[1,1]
    v_pk_mul_f32 v[86:87], v[86:87], v[54:55] op_sel:[0,1] op_sel_hi:[1,1]
    v_cvt_pk_bf16_f32 v68, v80, v81
    v_cvt_pk_bf16_f32 v69, v82, v83
    ds_write_b64 v25, v[66:67] offset:256
    s_waitcnt lgkmcnt(13)
    buffer_store_dwordx4 v[112:115], v50, s[16:19], s34 offen offset:0 nt
    v_accvgpr_read_b32 v76, a244
    v_accvgpr_read_b32 v77, a245
    v_accvgpr_read_b32 v78, a246
    v_accvgpr_read_b32 v79, a247
    v_pk_mul_f32 v[72:73], v[72:73], v[54:55] op_sel:[0,1] op_sel_hi:[1,1]
    v_pk_mul_f32 v[74:75], v[74:75], v[54:55] op_sel:[0,1] op_sel_hi:[1,1]
    v_cvt_pk_bf16_f32 v70, v84, v85
    v_cvt_pk_bf16_f32 v71, v86, v87
    ds_write_b64 v26, v[68:69] offset:256
    v_accvgpr_read_b32 v80, a248
    v_accvgpr_read_b32 v81, a249
    v_accvgpr_read_b32 v82, a250
    v_accvgpr_read_b32 v83, a251
    v_pk_mul_f32 v[76:77], v[76:77], v[54:55] op_sel:[0,1] op_sel_hi:[1,1]
    v_pk_mul_f32 v[78:79], v[78:79], v[54:55] op_sel:[0,1] op_sel_hi:[1,1]
    v_cvt_pk_bf16_f32 v64, v72, v73
    v_cvt_pk_bf16_f32 v65, v74, v75
    ds_write_b64 v27, v[70:71] offset:256
    s_waitcnt lgkmcnt(14)
    buffer_store_dwordx4 v[116:119], v50, s[16:19], s34 offen offset:1024 nt
    v_accvgpr_read_b32 v84, a252
    v_accvgpr_read_b32 v85, a253
    v_accvgpr_read_b32 v86, a254
    v_accvgpr_read_b32 v87, a255
    v_pk_mul_f32 v[80:81], v[80:81], v[54:55] op_sel:[0,1] op_sel_hi:[1,1]
    v_pk_mul_f32 v[82:83], v[82:83], v[54:55] op_sel:[0,1] op_sel_hi:[1,1]
    v_cvt_pk_bf16_f32 v66, v76, v77
    v_cvt_pk_bf16_f32 v67, v78, v79
    ds_write_b64 v61, v[64:65] offset:384
    v_pk_mul_f32 v[84:85], v[84:85], v[54:55] op_sel:[0,1] op_sel_hi:[1,1]
    v_pk_mul_f32 v[86:87], v[86:87], v[54:55] op_sel:[0,1] op_sel_hi:[1,1]
    v_cvt_pk_bf16_f32 v68, v80, v81
    v_cvt_pk_bf16_f32 v69, v82, v83
    ds_write_b64 v25, v[66:67] offset:384
    s_waitcnt lgkmcnt(15)
    buffer_store_dwordx4 v[120:123], v50, s[16:19], s34 offen offset:2048 nt
    v_cvt_pk_bf16_f32 v70, v84, v85
    v_cvt_pk_bf16_f32 v71, v86, v87
    ds_write_b64 v26, v[68:69] offset:384
    ds_write_b64 v27, v[70:71] offset:384
    s_waitcnt lgkmcnt(15)
    buffer_store_dwordx4 v[124:127], v50, s[16:19], s34 offen offset:3072 nt
    ds_read_b128 v[96:99], v49 offset:0
    ds_read_b128 v[100:103], v28 offset:1024
    ds_read_b128 v[104:107], v29 offset:2048
    ds_read_b128 v[108:111], v30 offset:3072
    ds_read_b128 v[112:115], v49 offset:4096
    ds_read_b128 v[116:119], v28 offset:5120
    ds_read_b128 v[120:123], v29 offset:6144
    ds_read_b128 v[124:127], v30 offset:7168
    s_add_u32 s33, s28, 24576
    s_add_u32 s34, s28, 28672
    s_waitcnt lgkmcnt(7)
    buffer_store_dwordx4 v[96:99], v50, s[16:19], s33 offen offset:0 nt
    s_waitcnt lgkmcnt(6)
    buffer_store_dwordx4 v[100:103], v50, s[16:19], s33 offen offset:1024 nt
    s_waitcnt lgkmcnt(5)
    buffer_store_dwordx4 v[104:107], v50, s[16:19], s33 offen offset:2048 nt
    s_waitcnt lgkmcnt(4)
    buffer_store_dwordx4 v[108:111], v50, s[16:19], s33 offen offset:3072 nt
    s_waitcnt lgkmcnt(3)
    buffer_store_dwordx4 v[112:115], v50, s[16:19], s34 offen offset:0 nt
    s_waitcnt lgkmcnt(2)
    buffer_store_dwordx4 v[116:119], v50, s[16:19], s34 offen offset:1024 nt
    s_waitcnt lgkmcnt(1)
    buffer_store_dwordx4 v[120:123], v50, s[16:19], s34 offen offset:2048 nt
    s_waitcnt lgkmcnt(0)
    buffer_store_dwordx4 v[124:127], v50, s[16:19], s34 offen offset:3072 nt
L_hot_end:
    s_branch L_end
L_stub_it0a:
    s_call_b64 s[80:81], L_slow1
    s_branch L_ret_it0a
L_stub_it0b:
    s_call_b64 s[80:81], L_slow0
    s_branch L_ret_it0b
L_stub_it0i15:
    s_call_b64 s[80:81], L_slow1
    s_branch L_ret_it0i15
L_stub_it1a:
    s_call_b64 s[80:81], L_slow1
    s_branch L_ret_it1a
L_stub_it1b:
    s_call_b64 s[80:81], L_slow0
    s_branch L_ret_it1b
L_stub_it1i15:
    s_call_b64 s[80:81], L_slow1
    s_branch L_ret_it1i15
L_slow0:
    s_nop 7
    s_add_u32 s33, s29, 0
    buffer_load_dwordx4 v[24:27], v48, s[8:11], s33 offen offset:0
    s_waitcnt vmcnt(0)
    v_mfma_f32_16x16x32_bf16 v[64:67], v[24:27], a[0:3], 0
    v_mfma_f32_16x16x32_bf16 v[72:75], v[24:27], a[32:35], 0
    v_mfma_f32_16x16x32_bf16 v[80:83], v[24:27], a[64:67], 0
    v_mfma_f32_16x16x32_bf16 v[88:91], v[24:27], a[96:99], 0
    s_nop 3
    buffer_load_dwordx4 v[24:27], v48, s[8:11], s33 offen offset:64
    s_waitcnt vmcnt(0)
    v_mfma_f32_16x16x32_bf16 v[64:67], v[24:27], a[4:7], v[64:67]
    v_mfma_f32_16x16x32_bf16 v[72:75], v[24:27], a[36:39], v[72:75]
    v_mfma_f32_16x16x32_bf16 v[80:83], v[24:27], a[68:71], v[80:83]
    v_mfma_f32_16x16x32_bf16 v[88:91], v[24:27], a[100:103], v[88:91]
    s_nop 3
    buffer_load_dwordx4 v[24:27], v48, s[8:11], s33 offen offset:128
    s_waitcnt vmcnt(0)
    v_mfma_f32_16x16x32_bf16 v[64:67], v[24:27], a[8:11], v[64:67]
    v_mfma_f32_16x16x32_bf16 v[72:75], v[24:27], a[40:43], v[72:75]
    v_mfma_f32_16x16x32_bf16 v[80:83], v[24:27], a[72:75], v[80:83]
    v_mfma_f32_16x16x32_bf16 v[88:91], v[24:27], a[104:107], v[88:91]
    s_nop 3
    buffer_load_dwordx4 v[24:27], v48, s[8:11], s33 offen offset:192
    s_waitcnt vmcnt(0)
    v_mfma_f32_16x16x32_bf16 v[64:67], v[24:27], a[12:15], v[64:67]
    v_mfma_f32_16x16x32_bf16 v[72:75], v[24:27], a[44:47], v[72:75]
    v_mfma_f32_16x16x32_bf16 v[80:83], v[24:27], a[76:79], v[80:83]
    v_mfma_f32_16x16x32_bf16 v[88:91], v[24:27], a[108:111], v[88:91]
    s_nop 3
    buffer_load_dwordx4 v[24:27], v48, s[8:11], s33 offen offset:256
    s_waitcnt vmcnt(0)
    v_mfma_f32_16x16x32_bf16 v[64:67], v[24:27], a[16:19], v[64:67]
    v_mfma_f32_16x16x32_bf16 v[72:75], v[24:27], a[48:51], v[72:75]
    v_mfma_f32_16x16x32_bf16 v[80:83], v[24:27], a[80:83], v[80:83]
    v_mfma_f32_16x16x32_bf16 v[88:91], v[24:27], a[112:115], v[88:91]
    s_nop 3
    buffer_load_dwordx4 v[24:27], v48, s[8:11], s33 offen offset:320
    s_waitcnt vmcnt(0)
    v_mfma_f32_16x16x32_bf16 v[64:67], v[24:27], a[20:23], v[64:67]
    v_mfma_f32_16x16x32_bf16 v[72:75], v[24:27], a[52:55], v[72:75]
    v_mfma_f32_16x16x32_bf16 v[80:83], v[24:27], a[84:87], v[80:83]
    v_mfma_f32_16x16x32_bf16 v[88:91], v[24:27], a[116:119], v[88:91]
    s_nop 3
    buffer_load_dwordx4 v[24:27], v48, s[8:11], s33 offen offset:384
    s_waitcnt vmcnt(0)
    v_mfma_f32_16x16x32_bf16 v[64:67], v[24:27], a[24:27], v[64:67]
    v_mfma_f32_16x16x32_bf16 v[72:75], v[24:27], a[56:59], v[72:75]
    v_mfma_f32_16x16x32_bf16 v[80:83], v[24:27], a[88:91], v[80:83]
    v_mfma_f32_16x16x32_bf16 v[88:91], v[24:27], a[120:123], v[88:91]
    s_nop 3
    buffer_load_dwordx4 v[24:27], v48, s[8:11], s33 offen offset:448
    s_waitcnt vmcnt(0)
    v_mfma_f32_16x16x32_bf16 v[64:67], v[24:27], a[28:31], v[64:67]
    v_mfma_f32_16x16x32_bf16 v[72:75], v[24:27], a[60:63], v[72:75]
    v_mfma_f32_16x16x32_bf16 v[80:83], v[24:27], a[92:95], v[80:83]
    v_mfma_f32_16x16x32_bf16 v[88:91], v[24:27], a[124:127], v[88:91]
    s_nop 3
    s_add_u32 s33, s29, 8192
    buffer_load_dwordx4 v[24:27], v48, s[8:11], s33 offen offset:0
    s_waitcnt vmcnt(0)
    v_mfma_f32_16x16x32_bf16 v[68:71], v[24:27], a[0:3], 0
    v_mfma_f32_16x16x32_bf16 v[76:79], v[24:27], a[32:35], 0
    v_mfma_f32_16x16x32_bf16 v[84:87], v[24:27], a[64:67], 0
    v_mfma_f32_16x16x32_bf16 v[92:95], v[24:27], a[96:99], 0
    s_nop 3
    buffer_load_dwordx4 v[24:27], v48, s[8:11], s33 offen offset:64
    s_waitcnt vmcnt(0)
    v_mfma_f32_16x16x32_bf16 v[68:71], v[24:27], a[4:7], v[68:71]
    v_mfma_f32_16x16x32_bf16 v[76:79], v[24:27], a[36:39], v[76:79]
    v_mfma_f32_16x16x32_bf16 v[84:87], v[24:27], a[68:71], v[84:87]
    v_mfma_f32_16x16x32_bf16 v[92:95], v[24:27], a[100:103], v[92:95]
    s_nop 3
    buffer_load_dwordx4 v[24:27], v48, s[8:11], s33 offen offset:128
    s_waitcnt vmcnt(0)
    v_mfma_f32_16x16x32_bf16 v[68:71], v[24:27], a[8:11], v[68:71]
    v_mfma_f32_16x16x32_bf16 v[76:79], v[24:27], a[40:43], v[76:79]
    v_mfma_f32_16x16x32_bf16 v[84:87], v[24:27], a[72:75], v[84:87]
    v_mfma_f32_16x16x32_bf16 v[92:95], v[24:27], a[104:107], v[92:95]
    s_nop 3
    buffer_load_dwordx4 v[24:27], v48, s[8:11], s33 offen offset:192
    s_waitcnt vmcnt(0)
    v_mfma_f32_16x16x32_bf16 v[68:71], v[24:27], a[12:15], v[68:71]
    v_mfma_f32_16x16x32_bf16 v[76:79], v[24:27], a[44:47], v[76:79]
    v_mfma_f32_16x16x32_bf16 v[84:87], v[24:27], a[76:79], v[84:87]
    v_mfma_f32_16x16x32_bf16 v[92:95], v[24:27], a[108:111], v[92:95]
    s_nop 3
    buffer_load_dwordx4 v[24:27], v48, s[8:11], s33 offen offset:256
    s_waitcnt vmcnt(0)
    v_mfma_f32_16x16x32_bf16 v[68:71], v[24:27], a[16:19], v[68:71]
    v_mfma_f32_16x16x32_bf16 v[76:79], v[24:27], a[48:51], v[76:79]
    v_mfma_f32_16x16x32_bf16 v[84:87], v[24:27], a[80:83], v[84:87]
    v_mfma_f32_16x16x32_bf16 v[92:95], v[24:27], a[112:115], v[92:95]
    s_nop 3
    buffer_load_dwordx4 v[24:27], v48, s[8:11], s33 offen offset:320
    s_waitcnt vmcnt(0)
    v_mfma_f32_16x16x32_bf16 v[68:71], v[24:27], a[20:23], v[68:71]
    v_mfma_f32_16x16x32_bf16 v[76:79], v[24:27], a[52:55], v[76:79]
    v_mfma_f32_16x16x32_bf16 v[84:87], v[24:27], a[84:87], v[84:87]
    v_mfma_f32_16x16x32_bf16 v[92:95], v[24:27], a[116:119], v[92:95]
    s_nop 3
    buffer_load_dwordx4 v[24:27], v48, s[8:11], s33 offen offset:384
    s_waitcnt vmcnt(0)
    v_mfma_f32_16x16x32_bf16 v[68:71], v[24:27], a[24:27], v[68:71]
    v_mfma_f32_16x16x32_bf16 v[76:79], v[24:27], a[56:59], v[76:79]
    v_mfma_f32_16x16x32_bf16 v[84:87], v[24:27], a[88:91], v[84:87]
    v_mfma_f32_16x16x32_bf16 v[92:95], v[24:27], a[120:123], v[92:95]
    s_nop 3
    buffer_load_dwordx4 v[24:27], v48, s[8:11], s33 offen offset:448
    s_waitcnt vmcnt(0)
    v_mfma_f32_16x16x32_bf16 v[68:71], v[24:27], a[28:31], v[68:71]
    v_mfma_f32_16x16x32_bf16 v[76:79], v[24:27], a[60:63], v[76:79]
    v_mfma_f32_16x16x32_bf16 v[84:87], v[24:27], a[92:95], v[84:87]
    v_mfma_f32_16x16x32_bf16 v[92:95], v[24:27], a[124:127], v[92:95]
    s_nop 3
    s_nop 7
    v_max3_f32 v18, v64, v65, v66
    v_max3_f32 v19, v72, v73, v74
    v_max3_f32 v20, v80, v81, v82
    v_max3_f32 v21, v88, v89, v90
    v_max3_f32 v18, v18, v67, v68
    v_max3_f32 v19, v19, v75, v76
    v_max3_f32 v20, v20, v83, v84
    v_max3_f32 v21, v21, v91, v92
    v_max3_f32 v18, v18, v69, v70
    v_max3_f32 v19, v19, v77, v78
    v_max3_f32 v20, v20, v85, v86
    v_max3_f32 v21, v21, v93, v94
    v_max_f32 v18, v18, v71
    v_max_f32 v19, v19, v79
    v_max_f32 v20, v20, v87
    v_max_f32 v21, v21, v95
    v_mov_b32 v24, v18
    v_mov_b32 v25, v19
    v_mov_b32 v26, v20
    v_mov_b32 v27, v21
    v_permlane32_swap_b32 v18, v24
    v_permlane32_swap_b32 v19, v25
    v_permlane32_swap_b32 v20, v26
    v_permlane32_swap_b32 v21, v27
    v_max_f32 v18, v18, v24
    v_max_f32 v19, v19, v25
    v_max_f32 v20, v20, v26
    v_max_f32 v21, v21, v27
    v_mov_b32 v24, v18
    v_mov_b32 v25, v19
    v_mov_b32 v26, v20
    v_mov_b32 v27, v21
    v_permlane16_swap_b32 v18, v24
    v_permlane16_swap_b32 v19, v25
    v_permlane16_swap_b32 v20, v26
    v_permlane16_swap_b32 v21, v27
    v_max_f32 v18, v18, v24
    v_max_f32 v19, v19, v25
    v_max_f32 v20, v20, v26
    v_max_f32 v21, v21, v27
    v_mul_f32 v18, s26, v18
    v_sub_f32 v18, 0, v18
    v_min_f32 v18, v18, v10
    v_sub_f32 v24, v18, v10
    v_exp_f32 v24, v24
    v_mov_b32 v10, v18
    v_mul_f32 v19, s26, v19
    v_sub_f32 v19, 0, v19
    v_min_f32 v19, v19, v11
    v_sub_f32 v25, v19, v11
    v_exp_f32 v25, v25
    v_mov_b32 v11, v19
    v_mul_f32 v20, s26, v20
    v_sub_f32 v20, 0, v20
    v_min_f32 v20, v20, v12
    v_sub_f32 v26, v20, v12
    v_exp_f32 v26, v26
    v_mov_b32 v12, v20
    v_mul_f32 v21, s26, v21
    v_sub_f32 v21, 0, v21
    v_min_f32 v21, v21, v13
    v_sub_f32 v27, v21, v13
    v_exp_f32 v27, v27
    v_mov_b32 v13, v21
    v_mul_f32 v14, v14, v24
    v_mul_f32 v15, v15, v25
    v_mul_f32 v16, v16, v26
    v_mul_f32 v17, v17, v27
    v_mul_f32 v128, v128, v24
    v_mul_f32 v129, v129, v24
    v_mul_f32 v130, v130, v24
    v_mul_f32 v131, v131, v24
    v_mul_f32 v132, v132, v24
    v_mul_f32 v133, v133, v24
    v_mul_f32 v134, v134, v24
    v_mul_f32 v135, v135, v24
    v_mul_f32 v136, v136, v24
    v_mul_f32 v137, v137, v24
    v_mul_f32 v138, v138, v24
    v_mul_f32 v139, v139, v24
    v_mul_f32 v140, v140, v24
    v_mul_f32 v141, v141, v24
    v_mul_f32 v142, v142, v24
    v_mul_f32 v143, v143, v24
    v_mul_f32 v144, v144, v24
    v_mul_f32 v145, v145, v24
    v_mul_f32 v146, v146, v24
    v_mul_f32 v147, v147, v24
    v_mul_f32 v148, v148, v24
    v_mul_f32 v149, v149, v24
    v_mul_f32 v150, v150, v24
    v_mul_f32 v151, v151, v24
    v_mul_f32 v152, v152, v24
    v_mul_f32 v153, v153, v24
    v_mul_f32 v154, v154, v24
    v_mul_f32 v155, v155, v24
    v_mul_f32 v156, v156, v24
    v_mul_f32 v157, v157, v24
    v_mul_f32 v158, v158, v24
    v_mul_f32 v159, v159, v24
    v_mul_f32 v160, v160, v24
    v_mul_f32 v161, v161, v24
    v_mul_f32 v162, v162, v24
    v_mul_f32 v163, v163, v24
    v_mul_f32 v164, v164, v24
    v_mul_f32 v165, v165, v24
    v_mul_f32 v166, v166, v24
    v_mul_f32 v167, v167, v24
    v_mul_f32 v168, v168, v24
    v_mul_f32 v169, v169, v24
    v_mul_f32 v170, v170, v24
    v_mul_f32 v171, v171, v24
    v_mul_f32 v172, v172, v24
    v_mul_f32 v173, v173, v24
    v_mul_f32 v174, v174, v24
    v_mul_f32 v175, v175, v24
    v_mul_f32 v176, v176, v24
    v_mul_f32 v177, v177, v24
    v_mul_f32 v178, v178, v24
    v_mul_f32 v179, v179, v24
    v_mul_f32 v180, v180, v24
    v_mul_f32 v181, v181, v24
    v_mul_f32 v182, v182, v24
    v_mul_f32 v183, v183, v24
    v_mul_f32 v184, v184, v24
    v_mul_f32 v185, v185, v24
    v_mul_f32 v186, v186, v24
    v_mul_f32 v187, v187, v24
    v_mul_f32 v188, v188, v24
    v_mul_f32 v189, v189, v24
    v_mul_f32 v190, v190, v24
    v_mul_f32 v191, v191, v24
    v_mul_f32 v192, v192, v25
    v_mul_f32 v193, v193, v25
    v_mul_f32 v194, v194, v25
    v_mul_f32 v195, v195, v25
    v_mul_f32 v196, v196, v25
    v_mul_f32 v197, v197, v25
    v_mul_f32 v198, v198, v25
    v_mul_f32 v199, v199, v25
    v_mul_f32 v200, v200, v25
    v_mul_f32 v201, v201, v25
    v_mul_f32 v202, v202, v25
    v_mul_f32 v203, v203, v25
    v_mul_f32 v204, v204, v25
    v_mul_f32 v205, v205, v25
    v_mul_f32 v206, v206, v25
    v_mul_f32 v207, v207, v25
    v_mul_f32 v208, v208, v25
    v_mul_f32 v209, v209, v25
    v_mul_f32 v210, v210, v25
    v_mul_f32 v211, v211, v25
    v_mul_f32 v212, v212, v25
    v_mul_f32 v213, v213, v25
    v_mul_f32 v214, v214, v25
    v_mul_f32 v215, v215, v25
    v_mul_f32 v216, v216, v25
    v_mul_f32 v217, v217, v25
    v_mul_f32 v218, v218, v25
    v_mul_f32 v219, v219, v25
    v_mul_f32 v220, v220, v25
    v_mul_f32 v221, v221, v25
    v_mul_f32 v222, v222, v25
    v_mul_f32 v223, v223, v25
    v_mul_f32 v224, v224, v25
    v_mul_f32 v225, v225, v25
    v_mul_f32 v226, v226, v25
    v_mul_f32 v227, v227, v25
    v_mul_f32 v228, v228, v25
    v_mul_f32 v229, v229, v25
    v_mul_f32 v230, v230, v25
    v_mul_f32 v231, v231, v25
    v_mul_f32 v232, v232, v25
    v_mul_f32 v233, v233, v25
    v_mul_f32 v234, v234, v25
    v_mul_f32 v235, v235, v25
    v_mul_f32 v236, v236, v25
    v_mul_f32 v237, v237, v25
    v_mul_f32 v238, v238, v25
    v_mul_f32 v239, v239, v25
    v_mul_f32 v240, v240, v25
    v_mul_f32 v241, v241, v25
    v_mul_f32 v242, v242, v25
    v_mul_f32 v243, v243, v25
    v_mul_f32 v244, v244, v25
    v_mul_f32 v245, v245, v25
    v_mul_f32 v246, v246, v25
    v_mul_f32 v247, v247, v25
    v_mul_f32 v248, v248, v25
    v_mul_f32 v249, v249, v25
    v_mul_f32 v250, v250, v25
    v_mul_f32 v251, v251, v25
    v_mul_f32 v252, v252, v25
    v_mul_f32 v253, v253, v25
    v_mul_f32 v254, v254, v25
    v_mul_f32 v255, v255, v25
    v_accvgpr_read_b32 v22, a128
    v_mul_f32 v22, v22, v26
    v_accvgpr_write_b32 a128, v22
    v_accvgpr_read_b32 v22, a129
    v_mul_f32 v22, v22, v26
    v_accvgpr_write_b32 a129, v22
    v_accvgpr_read_b32 v22, a130
    v_mul_f32 v22, v22, v26
    v_accvgpr_write_b32 a130, v22
    v_accvgpr_read_b32 v22, a131
    v_mul_f32 v22, v22, v26
    v_accvgpr_write_b32 a131, v22
    v_accvgpr_read_b32 v22, a132
    v_mul_f32 v22, v22, v26
    v_accvgpr_write_b32 a132, v22
    v_accvgpr_read_b32 v22, a133
    v_mul_f32 v22, v22, v26
    v_accvgpr_write_b32 a133, v22
    v_accvgpr_read_b32 v22, a134
    v_mul_f32 v22, v22, v26
    v_accvgpr_write_b32 a134, v22
    v_accvgpr_read_b32 v22, a135
    v_mul_f32 v22, v22, v26
    v_accvgpr_write_b32 a135, v22
    v_accvgpr_read_b32 v22, a136
    v_mul_f32 v22, v22, v26
    v_accvgpr_write_b32 a136, v22
    v_accvgpr_read_b32 v22, a137
    v_mul_f32 v22, v22, v26
    v_accvgpr_write_b32 a137, v22
    v_accvgpr_read_b32 v22, a138
    v_mul_f32 v22, v22, v26
    v_accvgpr_write_b32 a138, v22
    v_accvgpr_read_b32 v22, a139
    v_mul_f32 v22, v22, v26
    v_accvgpr_write_b32 a139, v22
    v_accvgpr_read_b32 v22, a140
    v_mul_f32 v22, v22, v26
    v_accvgpr_write_b32 a140, v22
    v_accvgpr_read_b32 v22, a141
    v_mul_f32 v22, v22, v26
    v_accvgpr_write_b32 a141, v22
    v_accvgpr_read_b32 v22, a142
    v_mul_f32 v22, v22, v26
    v_accvgpr_write_b32 a142, v22
    v_accvgpr_read_b32 v22, a143
    v_mul_f32 v22, v22, v26
    v_accvgpr_write_b32 a143, v22
    v_accvgpr_read_b32 v22, a144
    v_mul_f32 v22, v22, v26
    v_accvgpr_write_b32 a144, v22
    v_accvgpr_read_b32 v22, a145
    v_mul_f32 v22, v22, v26
    v_accvgpr_write_b32 a145, v22
    v_accvgpr_read_b32 v22, a146
    v_mul_f32 v22, v22, v26
    v_accvgpr_write_b32 a146, v22
    v_accvgpr_read_b32 v22, a147
    v_mul_f32 v22, v22, v26
    v_accvgpr_write_b32 a147, v22
    v_accvgpr_read_b32 v22, a148
    v_mul_f32 v22, v22, v26
    v_accvgpr_write_b32 a148, v22
    v_accvgpr_read_b32 v22, a149
    v_mul_f32 v22, v22, v26
    v_accvgpr_write_b32 a149, v22
    v_accvgpr_read_b32 v22, a150
    v_mul_f32 v22, v22, v26
    v_accvgpr_write_b32 a150, v22
    v_accvgpr_read_b32 v22, a151
    v_mul_f32 v22, v22, v26
    v_accvgpr_write_b32 a151, v22
    v_accvgpr_read_b32 v22, a152
    v_mul_f32 v22, v22, v26
    v_accvgpr_write_b32 a152, v22
    v_accvgpr_read_b32 v22, a153
    v_mul_f32 v22, v22, v26
    v_accvgpr_write_b32 a153, v22
    v_accvgpr_read_b32 v22, a154
    v_mul_f32 v22, v22, v26
    v_accvgpr_write_b32 a154, v22
    v_accvgpr_read_b32 v22, a155
    v_mul_f32 v22, v22, v26
    v_accvgpr_write_b32 a155, v22
    v_accvgpr_read_b32 v22, a156
    v_mul_f32 v22, v22, v26
    v_accvgpr_write_b32 a156, v22
    v_accvgpr_read_b32 v22, a157
    v_mul_f32 v22, v22, v26
    v_accvgpr_write_b32 a157, v22
    v_accvgpr_read_b32 v22, a158
    v_mul_f32 v22, v22, v26
    v_accvgpr_write_b32 a158, v22
    v_accvgpr_read_b32 v22, a159
    v_mul_f32 v22, v22, v26
    v_accvgpr_write_b32 a159, v22
    v_accvgpr_read_b32 v22, a160
    v_mul_f32 v22, v22, v26
    v_accvgpr_write_b32 a160, v22
    v_accvgpr_read_b32 v22, a161
    v_mul_f32 v22, v22, v26
    v_accvgpr_write_b32 a161, v22
    v_accvgpr_read_b32 v22, a162
    v_mul_f32 v22, v22, v26
    v_accvgpr_write_b32 a162, v22
    v_accvgpr_read_b32 v22, a163
    v_mul_f32 v22, v22, v26
    v_accvgpr_write_b32 a163, v22
    v_accvgpr_read_b32 v22, a164
    v_mul_f32 v22, v22, v26
    v_accvgpr_write_b32 a164, v22
    v_accvgpr_read_b32 v22, a165
    v_mul_f32 v22, v22, v26
    v_accvgpr_write_b32 a165, v22
    v_accvgpr_read_b32 v22, a166
    v_mul_f32 v22, v22, v26
    v_accvgpr_write_b32 a166, v22
    v_accvgpr_read_b32 v22, a167
    v_mul_f32 v22, v22, v26
    v_accvgpr_write_b32 a167, v22
    v_accvgpr_read_b32 v22, a168
    v_mul_f32 v22, v22, v26
    v_accvgpr_write_b32 a168, v22
    v_accvgpr_read_b32 v22, a169
    v_mul_f32 v22, v22, v26
    v_accvgpr_write_b32 a169, v22
    v_accvgpr_read_b32 v22, a170
    v_mul_f32 v22, v22, v26
    v_accvgpr_write_b32 a170, v22
    v_accvgpr_read_b32 v22, a171
    v_mul_f32 v22, v22, v26
    v_accvgpr_write_b32 a171, v22
    v_accvgpr_read_b32 v22, a172
    v_mul_f32 v22, v22, v26
    v_accvgpr_write_b32 a172, v22
    v_accvgpr_read_b32 v22, a173
    v_mul_f32 v22, v22, v26
    v_accvgpr_write_b32 a173, v22
    v_accvgpr_read_b32 v22, a174
    v_mul_f32 v22, v22, v26
    v_accvgpr_write_b32 a174, v22
    v_accvgpr_read_b32 v22, a175
    v_mul_f32 v22, v22, v26
    v_accvgpr_write_b32 a175, v22
    v_accvgpr_read_b32 v22, a176
    v_mul_f32 v22, v22, v26
    v_accvgpr_write_b32 a176, v22
    v_accvgpr_read_b32 v22, a177
    v_mul_f32 v22, v22, v26
    v_accvgpr_write_b32 a177, v22
    v_accvgpr_read_b32 v22, a178
    v_mul_f32 v22, v22, v26
    v_accvgpr_write_b32 a178, v22
    v_accvgpr_read_b32 v22, a179
    v_mul_f32 v22, v22, v26
    v_accvgpr_write_b32 a179, v22
    v_accvgpr_read_b32 v22, a180
    v_mul_f32 v22, v22, v26
    v_accvgpr_write_b32 a180, v22
    v_accvgpr_read_b32 v22, a181
    v_mul_f32 v22, v22, v26
    v_accvgpr_write_b32 a181, v22
    v_accvgpr_read_b32 v22, a182
    v_mul_f32 v22, v22, v26
    v_accvgpr_write_b32 a182, v22
    v_accvgpr_read_b32 v22, a183
    v_mul_f32 v22, v22, v26
    v_accvgpr_write_b32 a183, v22
    v_accvgpr_read_b32 v22, a184
    v_mul_f32 v22, v22, v26
    v_accvgpr_write_b32 a184, v22
    v_accvgpr_read_b32 v22, a185
    v_mul_f32 v22, v22, v26
    v_accvgpr_write_b32 a185, v22
    v_accvgpr_read_b32 v22, a186
    v_mul_f32 v22, v22, v26
    v_accvgpr_write_b32 a186, v22
    v_accvgpr_read_b32 v22, a187
    v_mul_f32 v22, v22, v26
    v_accvgpr_write_b32 a187, v22
    v_accvgpr_read_b32 v22, a188
    v_mul_f32 v22, v22, v26
    v_accvgpr_write_b32 a188, v22
    v_accvgpr_read_b32 v22, a189
    v_mul_f32 v22, v22, v26
    v_accvgpr_write_b32 a189, v22
    v_accvgpr_read_b32 v22, a190
    v_mul_f32 v22, v22, v26
    v_accvgpr_write_b32 a190, v22
    v_accvgpr_read_b32 v22, a191
    v_mul_f32 v22, v22, v26
    v_accvgpr_write_b32 a191, v22
    v_accvgpr_read_b32 v22, a192
    v_mul_f32 v22, v22, v27
    v_accvgpr_write_b32 a192, v22
    v_accvgpr_read_b32 v22, a193
    v_mul_f32 v22, v22, v27
    v_accvgpr_write_b32 a193, v22
    v_accvgpr_read_b32 v22, a194
    v_mul_f32 v22, v22, v27
    v_accvgpr_write_b32 a194, v22
    v_accvgpr_read_b32 v22, a195
    v_mul_f32 v22, v22, v27
    v_accvgpr_write_b32 a195, v22
    v_accvgpr_read_b32 v22, a196
    v_mul_f32 v22, v22, v27
    v_accvgpr_write_b32 a196, v22
    v_accvgpr_read_b32 v22, a197
    v_mul_f32 v22, v22, v27
    v_accvgpr_write_b32 a197, v22
    v_accvgpr_read_b32 v22, a198
    v_mul_f32 v22, v22, v27
    v_accvgpr_write_b32 a198, v22
    v_accvgpr_read_b32 v22, a199
    v_mul_f32 v22, v22, v27
    v_accvgpr_write_b32 a199, v22
    v_accvgpr_read_b32 v22, a200
    v_mul_f32 v22, v22, v27
    v_accvgpr_write_b32 a200, v22
    v_accvgpr_read_b32 v22, a201
    v_mul_f32 v22, v22, v27
    v_accvgpr_write_b32 a201, v22
    v_accvgpr_read_b32 v22, a202
    v_mul_f32 v22, v22, v27
    v_accvgpr_write_b32 a202, v22
    v_accvgpr_read_b32 v22, a203
    v_mul_f32 v22, v22, v27
    v_accvgpr_write_b32 a203, v22
    v_accvgpr_read_b32 v22, a204
    v_mul_f32 v22, v22, v27
    v_accvgpr_write_b32 a204, v22
    v_accvgpr_read_b32 v22, a205
    v_mul_f32 v22, v22, v27
    v_accvgpr_write_b32 a205, v22
    v_accvgpr_read_b32 v22, a206
    v_mul_f32 v22, v22, v27
    v_accvgpr_write_b32 a206, v22
    v_accvgpr_read_b32 v22, a207
    v_mul_f32 v22, v22, v27
    v_accvgpr_write_b32 a207, v22
    v_accvgpr_read_b32 v22, a208
    v_mul_f32 v22, v22, v27
    v_accvgpr_write_b32 a208, v22
    v_accvgpr_read_b32 v22, a209
    v_mul_f32 v22, v22, v27
    v_accvgpr_write_b32 a209, v22
    v_accvgpr_read_b32 v22, a210
    v_mul_f32 v22, v22, v27
    v_accvgpr_write_b32 a210, v22
    v_accvgpr_read_b32 v22, a211
    v_mul_f32 v22, v22, v27
    v_accvgpr_write_b32 a211, v22
    v_accvgpr_read_b32 v22, a212
    v_mul_f32 v22, v22, v27
    v_accvgpr_write_b32 a212, v22
    v_accvgpr_read_b32 v22, a213
    v_mul_f32 v22, v22, v27
    v_accvgpr_write_b32 a213, v22
    v_accvgpr_read_b32 v22, a214
    v_mul_f32 v22, v22, v27
    v_accvgpr_write_b32 a214, v22
    v_accvgpr_read_b32 v22, a215
    v_mul_f32 v22, v22, v27
    v_accvgpr_write_b32 a215, v22
    v_accvgpr_read_b32 v22, a216
    v_mul_f32 v22, v22, v27
    v_accvgpr_write_b32 a216, v22
    v_accvgpr_read_b32 v22, a217
    v_mul_f32 v22, v22, v27
    v_accvgpr_write_b32 a217, v22
    v_accvgpr_read_b32 v22, a218
    v_mul_f32 v22, v22, v27
    v_accvgpr_write_b32 a218, v22
    v_accvgpr_read_b32 v22, a219
    v_mul_f32 v22, v22, v27
    v_accvgpr_write_b32 a219, v22
    v_accvgpr_read_b32 v22, a220
    v_mul_f32 v22, v22, v27
    v_accvgpr_write_b32 a220, v22
    v_accvgpr_read_b32 v22, a221
    v_mul_f32 v22, v22, v27
    v_accvgpr_write_b32 a221, v22
    v_accvgpr_read_b32 v22, a222
    v_mul_f32 v22, v22, v27
    v_accvgpr_write_b32 a222, v22
    v_accvgpr_read_b32 v22, a223
    v_mul_f32 v22, v22, v27
    v_accvgpr_write_b32 a223, v22
    v_accvgpr_read_b32 v22, a224
    v_mul_f32 v22, v22, v27
    v_accvgpr_write_b32 a224, v22
    v_accvgpr_read_b32 v22, a225
    v_mul_f32 v22, v22, v27
    v_accvgpr_write_b32 a225, v22
    v_accvgpr_read_b32 v22, a226
    v_mul_f32 v22, v22, v27
    v_accvgpr_write_b32 a226, v22
    v_accvgpr_read_b32 v22, a227
    v_mul_f32 v22, v22, v27
    v_accvgpr_write_b32 a227, v22
    v_accvgpr_read_b32 v22, a228
    v_mul_f32 v22, v22, v27
    v_accvgpr_write_b32 a228, v22
    v_accvgpr_read_b32 v22, a229
    v_mul_f32 v22, v22, v27
    v_accvgpr_write_b32 a229, v22
    v_accvgpr_read_b32 v22, a230
    v_mul_f32 v22, v22, v27
    v_accvgpr_write_b32 a230, v22
    v_accvgpr_read_b32 v22, a231
    v_mul_f32 v22, v22, v27
    v_accvgpr_write_b32 a231, v22
    v_accvgpr_read_b32 v22, a232
    v_mul_f32 v22, v22, v27
    v_accvgpr_write_b32 a232, v22
    v_accvgpr_read_b32 v22, a233
    v_mul_f32 v22, v22, v27
    v_accvgpr_write_b32 a233, v22
    v_accvgpr_read_b32 v22, a234
    v_mul_f32 v22, v22, v27
    v_accvgpr_write_b32 a234, v22
    v_accvgpr_read_b32 v22, a235
    v_mul_f32 v22, v22, v27
    v_accvgpr_write_b32 a235, v22
    v_accvgpr_read_b32 v22, a236
    v_mul_f32 v22, v22, v27
    v_accvgpr_write_b32 a236, v22
    v_accvgpr_read_b32 v22, a237
    v_mul_f32 v22, v22, v27
    v_accvgpr_write_b32 a237, v22
    v_accvgpr_read_b32 v22, a238
    v_mul_f32 v22, v22, v27
    v_accvgpr_write_b32 a238, v22
    v_accvgpr_read_b32 v22, a239
    v_mul_f32 v22, v22, v27
    v_accvgpr_write_b32 a239, v22
    v_accvgpr_read_b32 v22, a240
    v_mul_f32 v22, v22, v27
    v_accvgpr_write_b32 a240, v22
    v_accvgpr_read_b32 v22, a241
    v_mul_f32 v22, v22, v27
    v_accvgpr_write_b32 a241, v22
    v_accvgpr_read_b32 v22, a242
    v_mul_f32 v22, v22, v27
    v_accvgpr_write_b32 a242, v22
    v_accvgpr_read_b32 v22, a243
    v_mul_f32 v22, v22, v27
    v_accvgpr_write_b32 a243, v22
    v_accvgpr_read_b32 v22, a244
    v_mul_f32 v22, v22, v27
    v_accvgpr_write_b32 a244, v22
    v_accvgpr_read_b32 v22, a245
    v_mul_f32 v22, v22, v27
    v_accvgpr_write_b32 a245, v22
    v_accvgpr_read_b32 v22, a246
    v_mul_f32 v22, v22, v27
    v_accvgpr_write_b32 a246, v22
    v_accvgpr_read_b32 v22, a247
    v_mul_f32 v22, v22, v27
    v_accvgpr_write_b32 a247, v22
    v_accvgpr_read_b32 v22, a248
    v_mul_f32 v22, v22, v27
    v_accvgpr_write_b32 a248, v22
    v_accvgpr_read_b32 v22, a249
    v_mul_f32 v22, v22, v27
    v_accvgpr_write_b32 a249, v22
    v_accvgpr_read_b32 v22, a250
    v_mul_f32 v22, v22, v27
    v_accvgpr_write_b32 a250, v22
    v_accvgpr_read_b32 v22, a251
    v_mul_f32 v22, v22, v27
    v_accvgpr_write_b32 a251, v22
    v_accvgpr_read_b32 v22, a252
    v_mul_f32 v22, v22, v27
    v_accvgpr_write_b32 a252, v22
    v_accvgpr_read_b32 v22, a253
    v_mul_f32 v22, v22, v27
    v_accvgpr_write_b32 a253, v22
    v_accvgpr_read_b32 v22, a254
    v_mul_f32 v22, v22, v27
    v_accvgpr_write_b32 a254, v22
    v_accvgpr_read_b32 v22, a255
    v_mul_f32 v22, v22, v27
    v_accvgpr_write_b32 a255, v22
    v_fma_f32 v64, v64, s26, v10
    v_fma_f32 v65, v65, s26, v10
    v_exp_f32 v64, v64
    v_exp_f32 v65, v65
    v_fma_f32 v66, v66, s26, v10
    v_fma_f32 v67, v67, s26, v10
    v_add_f32 v18, v64, v65
    v_cvt_pk_bf16_f32 v64, v64, v65
    v_exp_f32 v66, v66
    v_exp_f32 v67, v67
    v_fma_f32 v68, v68, s26, v10
    v_fma_f32 v69, v69, s26, v10
    v_add_f32 v18, v18, v66
    v_add_f32 v18, v18, v67
    v_cvt_pk_bf16_f32 v65, v66, v67
    v_exp_f32 v68, v68
    v_exp_f32 v69, v69
    v_fma_f32 v70, v70, s26, v10
    v_fma_f32 v71, v71, s26, v10
    v_add_f32 v18, v18, v68
    v_add_f32 v18, v18, v69
    v_cvt_pk_bf16_f32 v66, v68, v69
    v_exp_f32 v70, v70
    v_exp_f32 v71, v71
    v_fma_f32 v72, v72, s26, v11
    v_fma_f32 v73, v73, s26, v11
    v_add_f32 v18, v18, v70
    v_add_f32 v18, v18, v71
    v_cvt_pk_bf16_f32 v67, v70, v71
    v_exp_f32 v72, v72
    v_exp_f32 v73, v73
    v_fma_f32 v74, v74, s26, v11
    v_fma_f32 v75, v75, s26, v11
    v_add_f32 v19, v72, v73
    v_cvt_pk_bf16_f32 v72, v72, v73
    v_exp_f32 v74, v74
    v_exp_f32 v75, v75
    v_fma_f32 v76, v76, s26, v11
    v_fma_f32 v77, v77, s26, v11
    v_add_f32 v19, v19, v74
    v_add_f32 v19, v19, v75
    v_cvt_pk_bf16_f32 v73, v74, v75
    v_exp_f32 v76, v76
    v_exp_f32 v77, v77
    v_fma_f32 v78, v78, s26, v11
    v_fma_f32 v79, v79, s26, v11
    v_add_f32 v19, v19, v76
    v_add_f32 v19, v19, v77
    v_cvt_pk_bf16_f32 v74, v76, v77
    v_exp_f32 v78, v78
    v_exp_f32 v79, v79
    v_fma_f32 v80, v80, s26, v12
    v_fma_f32 v81, v81, s26, v12
    v_add_f32 v19, v19, v78
    v_add_f32 v19, v19, v79
    v_cvt_pk_bf16_f32 v75, v78, v79
    v_exp_f32 v80, v80
    v_exp_f32 v81, v81
    v_fma_f32 v82, v82, s26, v12
    v_fma_f32 v83, v83, s26, v12
    v_add_f32 v20, v80, v81
    v_cvt_pk_bf16_f32 v80, v80, v81
    v_exp_f32 v82, v82
    v_exp_f32 v83, v83
    v_fma_f32 v84, v84, s26, v12
    v_fma_f32 v85, v85, s26, v12
    v_add_f32 v20, v20, v82
    v_add_f32 v20, v20, v83
    v_cvt_pk_bf16_f32 v81, v82, v83
    v_exp_f32 v84, v84
    v_exp_f32 v85, v85
    v_fma_f32 v86, v86, s26, v12
    v_fma_f32 v87, v87, s26, v12
    v_add_f32 v20, v20, v84
    v_add_f32 v20, v20, v85
    v_cvt_pk_bf16_f32 v82, v84, v85
    v_exp_f32 v86, v86
    v_exp_f32 v87, v87
    v_fma_f32 v88, v88, s26, v13
    v_fma_f32 v89, v89, s26, v13
    v_add_f32 v20, v20, v86
    v_add_f32 v20, v20, v87
    v_cvt_pk_bf16_f32 v83, v86, v87
    v_exp_f32 v88, v88
    v_exp_f32 v89, v89
    v_fma_f32 v90, v90, s26, v13
    v_fma_f32 v91, v91, s26, v13
    v_add_f32 v21, v88, v89
    v_cvt_pk_bf16_f32 v88, v88, v89
    v_exp_f32 v90, v90
    v_exp_f32 v91, v91
    v_fma_f32 v92, v92, s26, v13
    v_fma_f32 v93, v93, s26, v13
    v_add_f32 v21, v21, v90
    v_add_f32 v21, v21, v91
    v_cvt_pk_bf16_f32 v89, v90, v91
    v_exp_f32 v92, v92
    v_exp_f32 v93, v93
    v_fma_f32 v94, v94, s26, v13
    v_fma_f32 v95, v95, s26, v13
    v_add_f32 v21, v21, v92
    v_add_f32 v21, v21, v93
    v_cvt_pk_bf16_f32 v90, v92, v93
    v_exp_f32 v94, v94
    v_exp_f32 v95, v95
    v_add_f32 v21, v21, v94
    v_add_f32 v21, v21, v95
    v_cvt_pk_bf16_f32 v91, v94, v95
    s_nop 1
    s_setpc_b64 s[80:81]
L_slow1:
    s_nop 7
    s_add_u32 s33, s29, 0
    buffer_load_dwordx4 v[24:27], v48, s[8:11], s33 offen offset:0
    s_waitcnt vmcnt(0)
    v_mfma_f32_16x16x32_bf16 v[96:99], v[24:27], a[0:3], 0
    v_mfma_f32_16x16x32_bf16 v[104:107], v[24:27], a[32:35], 0
    v_mfma_f32_16x16x32_bf16 v[112:115], v[24:27], a[64:67], 0
    v_mfma_f32_16x16x32_bf16 v[120:123], v[24:27], a[96:99], 0
    s_nop 3
    buffer_load_dwordx4 v[24:27], v48, s[8:11], s33 offen offset:64
    s_waitcnt vmcnt(0)
    v_mfma_f32_16x16x32_bf16 v[96:99], v[24:27], a[4:7], v[96:99]
    v_mfma_f32_16x16x32_bf16 v[104:107], v[24:27], a[36:39], v[104:107]
    v_mfma_f32_16x16x32_bf16 v[112:115], v[24:27], a[68:71], v[112:115]
    v_mfma_f32_16x16x32_bf16 v[120:123], v[24:27], a[100:103], v[120:123]
    s_nop 3
    buffer_load_dwordx4 v[24:27], v48, s[8:11], s33 offen offset:128
    s_waitcnt vmcnt(0)
    v_mfma_f32_16x16x32_bf16 v[96:99], v[24:27], a[8:11], v[96:99]
    v_mfma_f32_16x16x32_bf16 v[104:107], v[24:27], a[40:43], v[104:107]
    v_mfma_f32_16x16x32_bf16 v[112:115], v[24:27], a[72:75], v[112:115]
    v_mfma_f32_16x16x32_bf16 v[120:123], v[24:27], a[104:107], v[120:123]
    s_nop 3
    buffer_load_dwordx4 v[24:27], v48, s[8:11], s33 offen offset:192
    s_waitcnt vmcnt(0)
    v_mfma_f32_16x16x32_bf16 v[96:99], v[24:27], a[12:15], v[96:99]
    v_mfma_f32_16x16x32_bf16 v[104:107], v[24:27], a[44:47], v[104:107]
    v_mfma_f32_16x16x32_bf16 v[112:115], v[24:27], a[76:79], v[112:115]
    v_mfma_f32_16x16x32_bf16 v[120:123], v[24:27], a[108:111], v[120:123]
    s_nop 3
    buffer_load_dwordx4 v[24:27], v48, s[8:11], s33 offen offset:256
    s_waitcnt vmcnt(0)
    v_mfma_f32_16x16x32_bf16 v[96:99], v[24:27], a[16:19], v[96:99]
    v_mfma_f32_16x16x32_bf16 v[104:107], v[24:27], a[48:51], v[104:107]
    v_mfma_f32_16x16x32_bf16 v[112:115], v[24:27], a[80:83], v[112:115]
    v_mfma_f32_16x16x32_bf16 v[120:123], v[24:27], a[112:115], v[120:123]
    s_nop 3
    buffer_load_dwordx4 v[24:27], v48, s[8:11], s33 offen offset:320
    s_waitcnt vmcnt(0)
    v_mfma_f32_16x16x32_bf16 v[96:99], v[24:27], a[20:23], v[96:99]
    v_mfma_f32_16x16x32_bf16 v[104:107], v[24:27], a[52:55], v[104:107]
    v_mfma_f32_16x16x32_bf16 v[112:115], v[24:27], a[84:87], v[112:115]
    v_mfma_f32_16x16x32_bf16 v[120:123], v[24:27], a[116:119], v[120:123]
    s_nop 3
    buffer_load_dwordx4 v[24:27], v48, s[8:11], s33 offen offset:384
    s_waitcnt vmcnt(0)
    v_mfma_f32_16x16x32_bf16 v[96:99], v[24:27], a[24:27], v[96:99]
    v_mfma_f32_16x16x32_bf16 v[104:107], v[24:27], a[56:59], v[104:107]
    v_mfma_f32_16x16x32_bf16 v[112:115], v[24:27], a[88:91], v[112:115]
    v_mfma_f32_16x16x32_bf16 v[120:123], v[24:27], a[120:123], v[120:123]
    s_nop 3
    buffer_load_dwordx4 v[24:27], v48, s[8:11], s33 offen offset:448
    s_waitcnt vmcnt(0)
    v_mfma_f32_16x16x32_bf16 v[96:99], v[24:27], a[28:31], v[96:99]
    v_mfma_f32_16x16x32_bf16 v[104:107], v[24:27], a[60:63], v[104:107]
    v_mfma_f32_16x16x32_bf16 v[112:115], v[24:27], a[92:95], v[112:115]
    v_mfma_f32_16x16x32_bf16 v[120:123], v[24:27], a[124:127], v[120:123]
    s_nop 3
    s_add_u32 s33, s29, 8192
    buffer_load_dwordx4 v[24:27], v48, s[8:11], s33 offen offset:0
    s_waitcnt vmcnt(0)
    v_mfma_f32_16x16x32_bf16 v[100:103], v[24:27], a[0:3], 0
    v_mfma_f32_16x16x32_bf16 v[108:111], v[24:27], a[32:35], 0
    v_mfma_f32_16x16x32_bf16 v[116:119], v[24:27], a[64:67], 0
    v_mfma_f32_16x16x32_bf16 v[124:127], v[24:27], a[96:99], 0
    s_nop 3
    buffer_load_dwordx4 v[24:27], v48, s[8:11], s33 offen offset:64
    s_waitcnt vmcnt(0)
    v_mfma_f32_16x16x32_bf16 v[100:103], v[24:27], a[4:7], v[100:103]
    v_mfma_f32_16x16x32_bf16 v[108:111], v[24:27], a[36:39], v[108:111]
    v_mfma_f32_16x16x32_bf16 v[116:119], v[24:27], a[68:71], v[116:119]
    v_mfma_f32_16x16x32_bf16 v[124:127], v[24:27], a[100:103], v[124:127]
    s_nop 3
    buffer_load_dwordx4 v[24:27], v48, s[8:11], s33 offen offset:128
    s_waitcnt vmcnt(0)
    v_mfma_f32_16x16x32_bf16 v[100:103], v[24:27], a[8:11], v[100:103]
    v_mfma_f32_16x16x32_bf16 v[108:111], v[24:27], a[40:43], v[108:111]
    v_mfma_f32_16x16x32_bf16 v[116:119], v[24:27], a[72:75], v[116:119]
    v_mfma_f32_16x16x32_bf16 v[124:127], v[24:27], a[104:107], v[124:127]
    s_nop 3
    buffer_load_dwordx4 v[24:27], v48, s[8:11], s33 offen offset:192
    s_waitcnt vmcnt(0)
    v_mfma_f32_16x16x32_bf16 v[100:103], v[24:27], a[12:15], v[100:103]
    v_mfma_f32_16x16x32_bf16 v[108:111], v[24:27], a[44:47], v[108:111]
    v_mfma_f32_16x16x32_bf16 v[116:119], v[24:27], a[76:79], v[116:119]
    v_mfma_f32_16x16x32_bf16 v[124:127], v[24:27], a[108:111], v[124:127]
    s_nop 3
    buffer_load_dwordx4 v[24:27], v48, s[8:11], s33 offen offset:256
    s_waitcnt vmcnt(0)
    v_mfma_f32_16x16x32_bf16 v[100:103], v[24:27], a[16:19], v[100:103]
    v_mfma_f32_16x16x32_bf16 v[108:111], v[24:27], a[48:51], v[108:111]
    v_mfma_f32_16x16x32_bf16 v[116:119], v[24:27], a[80:83], v[116:119]
    v_mfma_f32_16x16x32_bf16 v[124:127], v[24:27], a[112:115], v[124:127]
    s_nop 3
    buffer_load_dwordx4 v[24:27], v48, s[8:11], s33 offen offset:320
    s_waitcnt vmcnt(0)
    v_mfma_f32_16x16x32_bf16 v[100:103], v[24:27], a[20:23], v[100:103]
    v_mfma_f32_16x16x32_bf16 v[108:111], v[24:27], a[52:55], v[108:111]
    v_mfma_f32_16x16x32_bf16 v[116:119], v[24:27], a[84:87], v[116:119]
    v_mfma_f32_16x16x32_bf16 v[124:127], v[24:27], a[116:119], v[124:127]
    s_nop 3
    buffer_load_dwordx4 v[24:27], v48, s[8:11], s33 offen offset:384
    s_waitcnt vmcnt(0)
    v_mfma_f32_16x16x32_bf16 v[100:103], v[24:27], a[24:27], v[100:103]
    v_mfma_f32_16x16x32_bf16 v[108:111], v[24:27], a[56:59], v[108:111]
    v_mfma_f32_16x16x32_bf16 v[116:119], v[24:27], a[88:91], v[116:119]
    v_mfma_f32_16x16x32_bf16 v[124:127], v[24:27], a[120:123], v[124:127]
    s_nop 3
    buffer_load_dwordx4 v[24:27], v48, s[8:11], s33 offen offset:448
    s_waitcnt vmcnt(0)
    v_mfma_f32_16x16x32_bf16 v[100:103], v[24:27], a[28:31], v[100:103]
    v_mfma_f32_16x16x32_bf16 v[108:111], v[24:27], a[60:63], v[108:111]
    v_mfma_f32_16x16x32_bf16 v[116:119], v[24:27], a[92:95], v[116:119]
    v_mfma_f32_16x16x32_bf16 v[124:127], v[24:27], a[124:127], v[124:127]
    s_nop 3
    s_nop 7
    v_max3_f32 v18, v96, v97, v98
    v_max3_f32 v19, v104, v105, v106
    v_max3_f32 v20, v112, v113, v114
    v_max3_f32 v21, v120, v121, v122
    v_max3_f32 v18, v18, v99, v100
    v_max3_f32 v19, v19, v107, v108
    v_max3_f32 v20, v20, v115, v116
    v_max3_f32 v21, v21, v123, v124
    v_max3_f32 v18, v18, v101, v102
    v_max3_f32 v19, v19, v109, v110
    v_max3_f32 v20, v20, v117, v118
    v_max3_f32 v21, v21, v125, v126
    v_max_f32 v18, v18, v103
    v_max_f32 v19, v19, v111
    v_max_f32 v20, v20, v119
    v_max_f32 v21, v21, v127
    v_mov_b32 v24, v18
    v_mov_b32 v25, v19
    v_mov_b32 v26, v20
    v_mov_b32 v27, v21
    v_permlane32_swap_b32 v18, v24
    v_permlane32_swap_b32 v19, v25
    v_permlane32_swap_b32 v20, v26
    v_permlane32_swap_b32 v21, v27
    v_max_f32 v18, v18, v24
    v_max_f32 v19, v19, v25
    v_max_f32 v20, v20, v26
    v_max_f32 v21, v21, v27
    v_mov_b32 v24, v18
    v_mov_b32 v25, v19
    v_mov_b32 v26, v20
    v_mov_b32 v27, v21
    v_permlane16_swap_b32 v18, v24
    v_permlane16_swap_b32 v19, v25
    v_permlane16_swap_b32 v20, v26
    v_permlane16_swap_b32 v21, v27
    v_max_f32 v18, v18, v24
    v_max_f32 v19, v19, v25
    v_max_f32 v20, v20, v26
    v_max_f32 v21, v21, v27
    v_mul_f32 v18, s26, v18
    v_sub_f32 v18, 0, v18
    v_min_f32 v18, v18, v10
    v_sub_f32 v24, v18, v10
    v_exp_f32 v24, v24
    v_mov_b32 v10, v18
    v_mul_f32 v19, s26, v19
    v_sub_f32 v19, 0, v19
    v_min_f32 v19, v19, v11
    v_sub_f32 v25, v19, v11
    v_exp_f32 v25, v25
    v_mov_b32 v11, v19
    v_mul_f32 v20, s26, v20
    v_sub_f32 v20, 0, v20
    v_min_f32 v20, v20, v12
    v_sub_f32 v26, v20, v12
    v_exp_f32 v26, v26
    v_mov_b32 v12, v20
    v_mul_f32 v21, s26, v21
    v_sub_f32 v21, 0, v21
    v_min_f32 v21, v21, v13
    v_sub_f32 v27, v21, v13
    v_exp_f32 v27, v27
    v_mov_b32 v13, v21
    v_mul_f32 v14, v14, v24
    v_mul_f32 v15, v15, v25
    v_mul_f32 v16, v16, v26
    v_mul_f32 v17, v17, v27
    v_mul_f32 v128, v128, v24
    v_mul_f32 v129, v129, v24
    v_mul_f32 v130, v130, v24
    v_mul_f32 v131, v131, v24
    v_mul_f32 v132, v132, v24
    v_mul_f32 v133, v133, v24
    v_mul_f32 v134, v134, v24
    v_mul_f32 v135, v135, v24
    v_mul_f32 v136, v136, v24
    v_mul_f32 v137, v137, v24
    v_mul_f32 v138, v138, v24
    v_mul_f32 v139, v139, v24
    v_mul_f32 v140, v140, v24
    v_mul_f32 v141, v141, v24
    v_mul_f32 v142, v142, v24
    v_mul_f32 v143, v143, v24
    v_mul_f32 v144, v144, v24
    v_mul_f32 v145, v145, v24
    v_mul_f32 v146, v146, v24
    v_mul_f32 v147, v147, v24
    v_mul_f32 v148, v148, v24
    v_mul_f32 v149, v149, v24
    v_mul_f32 v150, v150, v24
    v_mul_f32 v151, v151, v24
    v_mul_f32 v152, v152, v24
    v_mul_f32 v153, v153, v24
    v_mul_f32 v154, v154, v24
    v_mul_f32 v155, v155, v24
    v_mul_f32 v156, v156, v24
    v_mul_f32 v157, v157, v24
    v_mul_f32 v158, v158, v24
    v_mul_f32 v159, v159, v24
    v_mul_f32 v160, v160, v24
    v_mul_f32 v161, v161, v24
    v_mul_f32 v162, v162, v24
    v_mul_f32 v163, v163, v24
    v_mul_f32 v164, v164, v24
    v_mul_f32 v165, v165, v24
    v_mul_f32 v166, v166, v24
    v_mul_f32 v167, v167, v24
    v_mul_f32 v168, v168, v24
    v_mul_f32 v169, v169, v24
    v_mul_f32 v170, v170, v24
    v_mul_f32 v171, v171, v24
    v_mul_f32 v172, v172, v24
    v_mul_f32 v173, v173, v24
    v_mul_f32 v174, v174, v24
    v_mul_f32 v175, v175, v24
    v_mul_f32 v176, v176, v24
    v_mul_f32 v177, v177, v24
    v_mul_f32 v178, v178, v24
    v_mul_f32 v179, v179, v24
    v_mul_f32 v180, v180, v24
    v_mul_f32 v181, v181, v24
    v_mul_f32 v182, v182, v24
    v_mul_f32 v183, v183, v24
    v_mul_f32 v184, v184, v24
    v_mul_f32 v185, v185, v24
    v_mul_f32 v186, v186, v24
    v_mul_f32 v187, v187, v24
    v_mul_f32 v188, v188, v24
    v_mul_f32 v189, v189, v24
    v_mul_f32 v190, v190, v24
    v_mul_f32 v191, v191, v24
    v_mul_f32 v192, v192, v25
    v_mul_f32 v193, v193, v25
    v_mul_f32 v194, v194, v25
    v_mul_f32 v195, v195, v25
    v_mul_f32 v196, v196, v25
    v_mul_f32 v197, v197, v25
    v_mul_f32 v198, v198, v25
    v_mul_f32 v199, v199, v25
    v_mul_f32 v200, v200, v25
    v_mul_f32 v201, v201, v25
    v_mul_f32 v202, v202, v25
    v_mul_f32 v203, v203, v25
    v_mul_f32 v204, v204, v25
    v_mul_f32 v205, v205, v25
    v_mul_f32 v206, v206, v25
    v_mul_f32 v207, v207, v25
    v_mul_f32 v208, v208, v25
    v_mul_f32 v209, v209, v25
    v_mul_f32 v210, v210, v25
    v_mul_f32 v211, v211, v25
    v_mul_f32 v212, v212, v25
    v_mul_f32 v213, v213, v25
    v_mul_f32 v214, v214, v25
    v_mul_f32 v215, v215, v25
    v_mul_f32 v216, v216, v25
    v_mul_f32 v217, v217, v25
    v_mul_f32 v218, v218, v25
    v_mul_f32 v219, v219, v25
    v_mul_f32 v220, v220, v25
    v_mul_f32 v221, v221, v25
    v_mul_f32 v222, v222, v25
    v_mul_f32 v223, v223, v25
    v_mul_f32 v224, v224, v25
    v_mul_f32 v225, v225, v25
    v_mul_f32 v226, v226, v25
    v_mul_f32 v227, v227, v25
    v_mul_f32 v228, v228, v25
    v_mul_f32 v229, v229, v25
    v_mul_f32 v230, v230, v25
    v_mul_f32 v231, v231, v25
    v_mul_f32 v232, v232, v25
    v_mul_f32 v233, v233, v25
    v_mul_f32 v234, v234, v25
    v_mul_f32 v235, v235, v25
    v_mul_f32 v236, v236, v25
    v_mul_f32 v237, v237, v25
    v_mul_f32 v238, v238, v25
    v_mul_f32 v239, v239, v25
    v_mul_f32 v240, v240, v25
    v_mul_f32 v241, v241, v25
    v_mul_f32 v242, v242, v25
    v_mul_f32 v243, v243, v25
    v_mul_f32 v244, v244, v25
    v_mul_f32 v245, v245, v25
    v_mul_f32 v246, v246, v25
    v_mul_f32 v247, v247, v25
    v_mul_f32 v248, v248, v25
    v_mul_f32 v249, v249, v25
    v_mul_f32 v250, v250, v25
    v_mul_f32 v251, v251, v25
    v_mul_f32 v252, v252, v25
    v_mul_f32 v253, v253, v25
    v_mul_f32 v254, v254, v25
    v_mul_f32 v255, v255, v25
    v_accvgpr_read_b32 v22, a128
    v_mul_f32 v22, v22, v26
    v_accvgpr_write_b32 a128, v22
    v_accvgpr_read_b32 v22, a129
    v_mul_f32 v22, v22, v26
    v_accvgpr_write_b32 a129, v22
    v_accvgpr_read_b32 v22, a130
    v_mul_f32 v22, v22, v26
    v_accvgpr_write_b32 a130, v22
    v_accvgpr_read_b32 v22, a131
    v_mul_f32 v22, v22, v26
    v_accvgpr_write_b32 a131, v22
    v_accvgpr_read_b32 v22, a132
    v_mul_f32 v22, v22, v26
    v_accvgpr_write_b32 a132, v22
    v_accvgpr_read_b32 v22, a133
    v_mul_f32 v22, v22, v26
    v_accvgpr_write_b32 a133, v22
    v_accvgpr_read_b32 v22, a134
    v_mul_f32 v22, v22, v26
    v_accvgpr_write_b32 a134, v22
    v_accvgpr_read_b32 v22, a135
    v_mul_f32 v22, v22, v26
    v_accvgpr_write_b32 a135, v22
    v_accvgpr_read_b32 v22, a136
    v_mul_f32 v22, v22, v26
    v_accvgpr_write_b32 a136, v22
    v_accvgpr_read_b32 v22, a137
    v_mul_f32 v22, v22, v26
    v_accvgpr_write_b32 a137, v22
    v_accvgpr_read_b32 v22, a138
    v_mul_f32 v22, v22, v26
    v_accvgpr_write_b32 a138, v22
    v_accvgpr_read_b32 v22, a139
    v_mul_f32 v22, v22, v26
    v_accvgpr_write_b32 a139, v22
    v_accvgpr_read_b32 v22, a140
    v_mul_f32 v22, v22, v26
    v_accvgpr_write_b32 a140, v22
    v_accvgpr_read_b32 v22, a141
    v_mul_f32 v22, v22, v26
    v_accvgpr_write_b32 a141, v22
    v_accvgpr_read_b32 v22, a142
    v_mul_f32 v22, v22, v26
    v_accvgpr_write_b32 a142, v22
    v_accvgpr_read_b32 v22, a143
    v_mul_f32 v22, v22, v26
    v_accvgpr_write_b32 a143, v22
    v_accvgpr_read_b32 v22, a144
    v_mul_f32 v22, v22, v26
    v_accvgpr_write_b32 a144, v22
    v_accvgpr_read_b32 v22, a145
    v_mul_f32 v22, v22, v26
    v_accvgpr_write_b32 a145, v22
    v_accvgpr_read_b32 v22, a146
    v_mul_f32 v22, v22, v26
    v_accvgpr_write_b32 a146, v22
    v_accvgpr_read_b32 v22, a147
    v_mul_f32 v22, v22, v26
    v_accvgpr_write_b32 a147, v22
    v_accvgpr_read_b32 v22, a148
    v_mul_f32 v22, v22, v26
    v_accvgpr_write_b32 a148, v22
    v_accvgpr_read_b32 v22, a149
    v_mul_f32 v22, v22, v26
    v_accvgpr_write_b32 a149, v22
    v_accvgpr_read_b32 v22, a150
    v_mul_f32 v22, v22, v26
    v_accvgpr_write_b32 a150, v22
    v_accvgpr_read_b32 v22, a151
    v_mul_f32 v22, v22, v26
    v_accvgpr_write_b32 a151, v22
    v_accvgpr_read_b32 v22, a152
    v_mul_f32 v22, v22, v26
    v_accvgpr_write_b32 a152, v22
    v_accvgpr_read_b32 v22, a153
    v_mul_f32 v22, v22, v26
    v_accvgpr_write_b32 a153, v22
    v_accvgpr_read_b32 v22, a154
    v_mul_f32 v22, v22, v26
    v_accvgpr_write_b32 a154, v22
    v_accvgpr_read_b32 v22, a155
    v_mul_f32 v22, v22, v26
    v_accvgpr_write_b32 a155, v22
    v_accvgpr_read_b32 v22, a156
    v_mul_f32 v22, v22, v26
    v_accvgpr_write_b32 a156, v22
    v_accvgpr_read_b32 v22, a157
    v_mul_f32 v22, v22, v26
    v_accvgpr_write_b32 a157, v22
    v_accvgpr_read_b32 v22, a158
    v_mul_f32 v22, v22, v26
    v_accvgpr_write_b32 a158, v22
    v_accvgpr_read_b32 v22, a159
    v_mul_f32 v22, v22, v26
    v_accvgpr_write_b32 a159, v22
    v_accvgpr_read_b32 v22, a160
    v_mul_f32 v22, v22, v26
    v_accvgpr_write_b32 a160, v22
    v_accvgpr_read_b32 v22, a161
    v_mul_f32 v22, v22, v26
    v_accvgpr_write_b32 a161, v22
    v_accvgpr_read_b32 v22, a162
    v_mul_f32 v22, v22, v26
    v_accvgpr_write_b32 a162, v22
    v_accvgpr_read_b32 v22, a163
    v_mul_f32 v22, v22, v26
    v_accvgpr_write_b32 a163, v22
    v_accvgpr_read_b32 v22, a164
    v_mul_f32 v22, v22, v26
    v_accvgpr_write_b32 a164, v22
    v_accvgpr_read_b32 v22, a165
    v_mul_f32 v22, v22, v26
    v_accvgpr_write_b32 a165, v22
    v_accvgpr_read_b32 v22, a166
    v_mul_f32 v22, v22, v26
    v_accvgpr_write_b32 a166, v22
    v_accvgpr_read_b32 v22, a167
    v_mul_f32 v22, v22, v26
    v_accvgpr_write_b32 a167, v22
    v_accvgpr_read_b32 v22, a168
    v_mul_f32 v22, v22, v26
    v_accvgpr_write_b32 a168, v22
    v_accvgpr_read_b32 v22, a169
    v_mul_f32 v22, v22, v26
    v_accvgpr_write_b32 a169, v22
    v_accvgpr_read_b32 v22, a170
    v_mul_f32 v22, v22, v26
    v_accvgpr_write_b32 a170, v22
    v_accvgpr_read_b32 v22, a171
    v_mul_f32 v22, v22, v26
    v_accvgpr_write_b32 a171, v22
    v_accvgpr_read_b32 v22, a172
    v_mul_f32 v22, v22, v26
    v_accvgpr_write_b32 a172, v22
    v_accvgpr_read_b32 v22, a173
    v_mul_f32 v22, v22, v26
    v_accvgpr_write_b32 a173, v22
    v_accvgpr_read_b32 v22, a174
    v_mul_f32 v22, v22, v26
    v_accvgpr_write_b32 a174, v22
    v_accvgpr_read_b32 v22, a175
    v_mul_f32 v22, v22, v26
    v_accvgpr_write_b32 a175, v22
    v_accvgpr_read_b32 v22, a176
    v_mul_f32 v22, v22, v26
    v_accvgpr_write_b32 a176, v22
    v_accvgpr_read_b32 v22, a177
    v_mul_f32 v22, v22, v26
    v_accvgpr_write_b32 a177, v22
    v_accvgpr_read_b32 v22, a178
    v_mul_f32 v22, v22, v26
    v_accvgpr_write_b32 a178, v22
    v_accvgpr_read_b32 v22, a179
    v_mul_f32 v22, v22, v26
    v_accvgpr_write_b32 a179, v22
    v_accvgpr_read_b32 v22, a180
    v_mul_f32 v22, v22, v26
    v_accvgpr_write_b32 a180, v22
    v_accvgpr_read_b32 v22, a181
    v_mul_f32 v22, v22, v26
    v_accvgpr_write_b32 a181, v22
    v_accvgpr_read_b32 v22, a182
    v_mul_f32 v22, v22, v26
    v_accvgpr_write_b32 a182, v22
    v_accvgpr_read_b32 v22, a183
    v_mul_f32 v22, v22, v26
    v_accvgpr_write_b32 a183, v22
    v_accvgpr_read_b32 v22, a184
    v_mul_f32 v22, v22, v26
    v_accvgpr_write_b32 a184, v22
    v_accvgpr_read_b32 v22, a185
    v_mul_f32 v22, v22, v26
    v_accvgpr_write_b32 a185, v22
    v_accvgpr_read_b32 v22, a186
    v_mul_f32 v22, v22, v26
    v_accvgpr_write_b32 a186, v22
    v_accvgpr_read_b32 v22, a187
    v_mul_f32 v22, v22, v26
    v_accvgpr_write_b32 a187, v22
    v_accvgpr_read_b32 v22, a188
    v_mul_f32 v22, v22, v26
    v_accvgpr_write_b32 a188, v22
    v_accvgpr_read_b32 v22, a189
    v_mul_f32 v22, v22, v26
    v_accvgpr_write_b32 a189, v22
    v_accvgpr_read_b32 v22, a190
    v_mul_f32 v22, v22, v26
    v_accvgpr_write_b32 a190, v22
    v_accvgpr_read_b32 v22, a191
    v_mul_f32 v22, v22, v26
    v_accvgpr_write_b32 a191, v22
    v_accvgpr_read_b32 v22, a192
    v_mul_f32 v22, v22, v27
    v_accvgpr_write_b32 a192, v22
    v_accvgpr_read_b32 v22, a193
    v_mul_f32 v22, v22, v27
    v_accvgpr_write_b32 a193, v22
    v_accvgpr_read_b32 v22, a194
    v_mul_f32 v22, v22, v27
    v_accvgpr_write_b32 a194, v22
    v_accvgpr_read_b32 v22, a195
    v_mul_f32 v22, v22, v27
    v_accvgpr_write_b32 a195, v22
    v_accvgpr_read_b32 v22, a196
    v_mul_f32 v22, v22, v27
    v_accvgpr_write_b32 a196, v22
    v_accvgpr_read_b32 v22, a197
    v_mul_f32 v22, v22, v27
    v_accvgpr_write_b32 a197, v22
    v_accvgpr_read_b32 v22, a198
    v_mul_f32 v22, v22, v27
    v_accvgpr_write_b32 a198, v22
    v_accvgpr_read_b32 v22, a199
    v_mul_f32 v22, v22, v27
    v_accvgpr_write_b32 a199, v22
    v_accvgpr_read_b32 v22, a200
    v_mul_f32 v22, v22, v27
    v_accvgpr_write_b32 a200, v22
    v_accvgpr_read_b32 v22, a201
    v_mul_f32 v22, v22, v27
    v_accvgpr_write_b32 a201, v22
    v_accvgpr_read_b32 v22, a202
    v_mul_f32 v22, v22, v27
    v_accvgpr_write_b32 a202, v22
    v_accvgpr_read_b32 v22, a203
    v_mul_f32 v22, v22, v27
    v_accvgpr_write_b32 a203, v22
    v_accvgpr_read_b32 v22, a204
    v_mul_f32 v22, v22, v27
    v_accvgpr_write_b32 a204, v22
    v_accvgpr_read_b32 v22, a205
    v_mul_f32 v22, v22, v27
    v_accvgpr_write_b32 a205, v22
    v_accvgpr_read_b32 v22, a206
    v_mul_f32 v22, v22, v27
    v_accvgpr_write_b32 a206, v22
    v_accvgpr_read_b32 v22, a207
    v_mul_f32 v22, v22, v27
    v_accvgpr_write_b32 a207, v22
    v_accvgpr_read_b32 v22, a208
    v_mul_f32 v22, v22, v27
    v_accvgpr_write_b32 a208, v22
    v_accvgpr_read_b32 v22, a209
    v_mul_f32 v22, v22, v27
    v_accvgpr_write_b32 a209, v22
    v_accvgpr_read_b32 v22, a210
    v_mul_f32 v22, v22, v27
    v_accvgpr_write_b32 a210, v22
    v_accvgpr_read_b32 v22, a211
    v_mul_f32 v22, v22, v27
    v_accvgpr_write_b32 a211, v22
    v_accvgpr_read_b32 v22, a212
    v_mul_f32 v22, v22, v27
    v_accvgpr_write_b32 a212, v22
    v_accvgpr_read_b32 v22, a213
    v_mul_f32 v22, v22, v27
    v_accvgpr_write_b32 a213, v22
    v_accvgpr_read_b32 v22, a214
    v_mul_f32 v22, v22, v27
    v_accvgpr_write_b32 a214, v22
    v_accvgpr_read_b32 v22, a215
    v_mul_f32 v22, v22, v27
    v_accvgpr_write_b32 a215, v22
    v_accvgpr_read_b32 v22, a216
    v_mul_f32 v22, v22, v27
    v_accvgpr_write_b32 a216, v22
    v_accvgpr_read_b32 v22, a217
    v_mul_f32 v22, v22, v27
    v_accvgpr_write_b32 a217, v22
    v_accvgpr_read_b32 v22, a218
    v_mul_f32 v22, v22, v27
    v_accvgpr_write_b32 a218, v22
    v_accvgpr_read_b32 v22, a219
    v_mul_f32 v22, v22, v27
    v_accvgpr_write_b32 a219, v22
    v_accvgpr_read_b32 v22, a220
    v_mul_f32 v22, v22, v27
    v_accvgpr_write_b32 a220, v22
    v_accvgpr_read_b32 v22, a221
    v_mul_f32 v22, v22, v27
    v_accvgpr_write_b32 a221, v22
    v_accvgpr_read_b32 v22, a222
    v_mul_f32 v22, v22, v27
    v_accvgpr_write_b32 a222, v22
    v_accvgpr_read_b32 v22, a223
    v_mul_f32 v22, v22, v27
    v_accvgpr_write_b32 a223, v22
    v_accvgpr_read_b32 v22, a224
    v_mul_f32 v22, v22, v27
    v_accvgpr_write_b32 a224, v22
    v_accvgpr_read_b32 v22, a225
    v_mul_f32 v22, v22, v27
    v_accvgpr_write_b32 a225, v22
    v_accvgpr_read_b32 v22, a226
    v_mul_f32 v22, v22, v27
    v_accvgpr_write_b32 a226, v22
    v_accvgpr_read_b32 v22, a227
    v_mul_f32 v22, v22, v27
    v_accvgpr_write_b32 a227, v22
    v_accvgpr_read_b32 v22, a228
    v_mul_f32 v22, v22, v27
    v_accvgpr_write_b32 a228, v22
    v_accvgpr_read_b32 v22, a229
    v_mul_f32 v22, v22, v27
    v_accvgpr_write_b32 a229, v22
    v_accvgpr_read_b32 v22, a230
    v_mul_f32 v22, v22, v27
    v_accvgpr_write_b32 a230, v22
    v_accvgpr_read_b32 v22, a231
    v_mul_f32 v22, v22, v27
    v_accvgpr_write_b32 a231, v22
    v_accvgpr_read_b32 v22, a232
    v_mul_f32 v22, v22, v27
    v_accvgpr_write_b32 a232, v22
    v_accvgpr_read_b32 v22, a233
    v_mul_f32 v22, v22, v27
    v_accvgpr_write_b32 a233, v22
    v_accvgpr_read_b32 v22, a234
    v_mul_f32 v22, v22, v27
    v_accvgpr_write_b32 a234, v22
    v_accvgpr_read_b32 v22, a235
    v_mul_f32 v22, v22, v27
    v_accvgpr_write_b32 a235, v22
    v_accvgpr_read_b32 v22, a236
    v_mul_f32 v22, v22, v27
    v_accvgpr_write_b32 a236, v22
    v_accvgpr_read_b32 v22, a237
    v_mul_f32 v22, v22, v27
    v_accvgpr_write_b32 a237, v22
    v_accvgpr_read_b32 v22, a238
    v_mul_f32 v22, v22, v27
    v_accvgpr_write_b32 a238, v22
    v_accvgpr_read_b32 v22, a239
    v_mul_f32 v22, v22, v27
    v_accvgpr_write_b32 a239, v22
    v_accvgpr_read_b32 v22, a240
    v_mul_f32 v22, v22, v27
    v_accvgpr_write_b32 a240, v22
    v_accvgpr_read_b32 v22, a241
    v_mul_f32 v22, v22, v27
    v_accvgpr_write_b32 a241, v22
    v_accvgpr_read_b32 v22, a242
    v_mul_f32 v22, v22, v27
    v_accvgpr_write_b32 a242, v22
    v_accvgpr_read_b32 v22, a243
    v_mul_f32 v22, v22, v27
    v_accvgpr_write_b32 a243, v22
    v_accvgpr_read_b32 v22, a244
    v_mul_f32 v22, v22, v27
    v_accvgpr_write_b32 a244, v22
    v_accvgpr_read_b32 v22, a245
    v_mul_f32 v22, v22, v27
    v_accvgpr_write_b32 a245, v22
    v_accvgpr_read_b32 v22, a246
    v_mul_f32 v22, v22, v27
    v_accvgpr_write_b32 a246, v22
    v_accvgpr_read_b32 v22, a247
    v_mul_f32 v22, v22, v27
    v_accvgpr_write_b32 a247, v22
    v_accvgpr_read_b32 v22, a248
    v_mul_f32 v22, v22, v27
    v_accvgpr_write_b32 a248, v22
    v_accvgpr_read_b32 v22, a249
    v_mul_f32 v22, v22, v27
    v_accvgpr_write_b32 a249, v22
    v_accvgpr_read_b32 v22, a250
    v_mul_f32 v22, v22, v27
    v_accvgpr_write_b32 a250, v22
    v_accvgpr_read_b32 v22, a251
    v_mul_f32 v22, v22, v27
    v_accvgpr_write_b32 a251, v22
    v_accvgpr_read_b32 v22, a252
    v_mul_f32 v22, v22, v27
    v_accvgpr_write_b32 a252, v22
    v_accvgpr_read_b32 v22, a253
    v_mul_f32 v22, v22, v27
    v_accvgpr_write_b32 a253, v22
    v_accvgpr_read_b32 v22, a254
    v_mul_f32 v22, v22, v27
    v_accvgpr_write_b32 a254, v22
    v_accvgpr_read_b32 v22, a255
    v_mul_f32 v22, v22, v27
    v_accvgpr_write_b32 a255, v22
    v_fma_f32 v96, v96, s26, v10
    v_fma_f32 v97, v97, s26, v10
    v_exp_f32 v96, v96
    v_exp_f32 v97, v97
    v_fma_f32 v98, v98, s26, v10
    v_fma_f32 v99, v99, s26, v10
    v_add_f32 v18, v96, v97
    v_cvt_pk_bf16_f32 v96, v96, v97
    v_exp_f32 v98, v98
    v_exp_f32 v99, v99
    v_fma_f32 v100, v100, s26, v10
    v_fma_f32 v101, v101, s26, v10
    v_add_f32 v18, v18, v98
    v_add_f32 v18, v18, v99
    v_cvt_pk_bf16_f32 v97, v98, v99
    v_exp_f32 v100, v100
    v_exp_f32 v101, v101
    v_fma_f32 v102, v102, s26, v10
    v_fma_f32 v103, v103, s26, v10
    v_add_f32 v18, v18, v100
    v_add_f32 v18, v18, v101
    v_cvt_pk_bf16_f32 v98, v100, v101
    v_exp_f32 v102, v102
    v_exp_f32 v103, v103
    v_fma_f32 v104, v104, s26, v11
    v_fma_f32 v105, v105, s26, v11
    v_add_f32 v18, v18, v102
    v_add_f32 v18, v18, v103
    v_cvt_pk_bf16_f32 v99, v102, v103
    v_exp_f32 v104, v104
    v_exp_f32 v105, v105
    v_fma_f32 v106, v106, s26, v11
    v_fma_f32 v107, v107, s26, v11
    v_add_f32 v19, v104, v105
    v_cvt_pk_bf16_f32 v104, v104, v105
    v_exp_f32 v106, v106
    v_exp_f32 v107, v107
    v_fma_f32 v108, v108, s26, v11
    v_fma_f32 v109, v109, s26, v11
    v_add_f32 v19, v19, v106
    v_add_f32 v19, v19, v107
    v_cvt_pk_bf16_f32 v105, v106, v107
    v_exp_f32 v108, v108
    v_exp_f32 v109, v109
    v_fma_f32 v110, v110, s26, v11
    v_fma_f32 v111, v111, s26, v11
    v_add_f32 v19, v19, v108
    v_add_f32 v19, v19, v109
    v_cvt_pk_bf16_f32 v106, v108, v109
    v_exp_f32 v110, v110
    v_exp_f32 v111, v111
    v_fma_f32 v112, v112, s26, v12
    v_fma_f32 v113, v113, s26, v12
    v_add_f32 v19, v19, v110
    v_add_f32 v19, v19, v111
    v_cvt_pk_bf16_f32 v107, v110, v111
    v_exp_f32 v112, v112
    v_exp_f32 v113, v113
    v_fma_f32 v114, v114, s26, v12
    v_fma_f32 v115, v115, s26, v12
    v_add_f32 v20, v112, v113
    v_cvt_pk_bf16_f32 v112, v112, v113
    v_exp_f32 v114, v114
    v_exp_f32 v115, v115
    v_fma_f32 v116, v116, s26, v12
    v_fma_f32 v117, v117, s26, v12
    v_add_f32 v20, v20, v114
    v_add_f32 v20, v20, v115
    v_cvt_pk_bf16_f32 v113, v114, v115
    v_exp_f32 v116, v116
    v_exp_f32 v117, v117
    v_fma_f32 v118, v118, s26, v12
    v_fma_f32 v119, v119, s26, v12
    v_add_f32 v20, v20, v116
    v_add_f32 v20, v20, v117
    v_cvt_pk_bf16_f32 v114, v116, v117
    v_exp_f32 v118, v118
    v_exp_f32 v119, v119
    v_fma_f32 v120, v120, s26, v13
    v_fma_f32 v121, v121, s26, v13
    v_add_f32 v20, v20, v118
    v_add_f32 v20, v20, v119
    v_cvt_pk_bf16_f32 v115, v118, v119
    v_exp_f32 v120, v120
    v_exp_f32 v121, v121
    v_fma_f32 v122, v122, s26, v13
    v_fma_f32 v123, v123, s26, v13
    v_add_f32 v21, v120, v121
    v_cvt_pk_bf16_f32 v120, v120, v121
    v_exp_f32 v122, v122
    v_exp_f32 v123, v123
    v_fma_f32 v124, v124, s26, v13
    v_fma_f32 v125, v125, s26, v13
    v_add_f32 v21, v21, v122
    v_add_f32 v21, v21, v123
    v_cvt_pk_bf16_f32 v121, v122, v123
    v_exp_f32 v124, v124
    v_exp_f32 v125, v125
    v_fma_f32 v126, v126, s26, v13
    v_fma_f32 v127, v127, s26, v13
    v_add_f32 v21, v21, v124
    v_add_f32 v21, v21, v125
    v_cvt_pk_bf16_f32 v122, v124, v125
    v_exp_f32 v126, v126
    v_exp_f32 v127, v127
    v_add_f32 v21, v21, v126
    v_add_f32 v21, v21, v127
    v_cvt_pk_bf16_f32 v123, v126, v127
    s_nop 1
    s_setpc_b64 s[80:81]
L_code_end:
L_end:
    s_endpgm
.section .rodata,"a"
.p2align 6
.amdhsa_kernel standalone__gqa_softmax__near_ridge_kernel
  .amdhsa_next_free_vgpr 512
  .amdhsa_next_free_sgpr 102
  .amdhsa_accum_offset 256
  .amdhsa_group_segment_fixed_size 0
  .amdhsa_kernarg_size 48
  .amdhsa_user_sgpr_count 2
  .amdhsa_user_sgpr_kernarg_segment_ptr 1
  .amdhsa_system_sgpr_workgroup_id_x 1
  .amdhsa_float_denorm_mode_32 3
.end_amdhsa_kernel
```
